```python
import torch

def _softmax(x, axis=-1):
    return torch.softmax(x, dim=axis)

def _gelu(x):
    return torch.nn.functional.gelu(x, approximate='tanh')

def _silu(x):
    return torch.nn.functional.silu(x)

def _sigmoid(x):
    return torch.sigmoid(x)

def _layernorm(x, axis=-1, eps=1e-05):
    m = x.mean(dim=axis, keepdim=True)
    v = x.var(dim=axis, keepdim=True, unbiased=False)
    return (x - m) / torch.sqrt(v + eps)

def _scatter_add(tgt, idx, src, axis=0):
    return tgt.clone().index_add_(axis, idx, src)

def _segment_sum(src, seg, n):
    out = torch.zeros((n,) + src.shape[1:], dtype=src.dtype)
    return out.index_add_(0, seg, src)

def _pad(x, pw):
    flat = tuple((v for pair in reversed(pw) for v in pair))
    return torch.nn.functional.pad(x, flat)
kernel_name = 'adaLN_cond__sliding_local_dilated__mixer_s_mlp__prompt'

def setup_inputs():

    _w = lambda a: (lambda t: t.to(torch.bfloat16) if t.is_floating_point() else t)(torch.as_tensor(a))

    def _A_setup():
        B, S, D = (1, 2048, 512)
        return {'x': _w((lambda *s: torch.randn(*s, dtype=torch.bfloat16) * 0.05)(B, S, D)), 'wqkv': _w((lambda *s: torch.randn(*s, dtype=torch.bfloat16) * 0.05)(D, 3 * D)), 'wo': _w((lambda *s: torch.randn(*s, dtype=torch.bfloat16) * 0.05)(D, D))}
    _A_in = _A_setup()

    def _B_setup():
        B, S, D, F = (1, 2048, 512, 1376)
        return {'x': _w((lambda *s: torch.randn(*s, dtype=torch.bfloat16) * 0.05)(B, S, D)), 'w1': _w((lambda *s: torch.randn(*s, dtype=torch.bfloat16) * 3.2)(D, D) * D ** (-0.5)), 'w2': _w((lambda *s: torch.randn(*s, dtype=torch.bfloat16) * 3.2)(D, D) * D ** (-0.5)), 'w3': _w((lambda *s: torch.randn(*s, dtype=torch.bfloat16) * 3.2)(D, F) * D ** (-0.5)), 'w4': _w((lambda *s: torch.randn(*s, dtype=torch.bfloat16) * 3.2)(F, D) * F ** (-0.5))}
    _B_in = _B_setup()
    return {'A_x': _A_in['x'], 'A_wqkv': _A_in['wqkv'], 'A_wo': _A_in['wo'], 'B_x': _B_in['x'], 'B_w1': _B_in['w1'], 'B_w2': _B_in['w2'], 'B_w3': _B_in['w3'], 'B_w4': _B_in['w4'], 'c': _w((lambda *s: torch.randn(*s, dtype=torch.bfloat16) * 0.1)(1, 512) * 8.0), 'w_mod': _w((lambda *s: torch.randn(*s, dtype=torch.bfloat16) * 0.1)(512, 6 * 512) * 512 ** (-0.5) * 8.0)}

def reference(A_x, A_wqkv, A_wo, B_x, B_w1, B_w2, B_w3, B_w4, c, w_mod):

    def _A_ref(x, wqkv, wo):
        B, S, D = x.shape
        H = 32
        Dh = D // H
        W, dil = (8, 2)
        qkv = (lambda x, *d: x.permute(*d))((x @ wqkv).reshape(B, S, 3, H, Dh), 2, 0, 3, 1, 4)
        q, k, v = (qkv[0], qkv[1], qkv[2])
        scale = Dh ** (-0.5)
        pos = torch.arange(S)
        off = torch.arange(W) * dil
        idx = pos[:, None] - off[None, :]
        mask = idx >= 0
        idx_c = torch.where(mask, idx, 0).reshape(-1)
        kg = k[:, :, idx_c, :].reshape(B, H, S, W, Dh)
        vg = v[:, :, idx_c, :].reshape(B, H, S, W, Dh)
        logits = torch.einsum('bhsd,bhswd->bhsw', q, kg) * scale
        logits = torch.where(mask[None, None, :, :], logits, -1000000000.0)
        attn = _softmax(logits, axis=-1)
        o = torch.einsum('bhsw,bhswd->bhsd', attn, vg)
        return (lambda x, *d: x.permute(*d))(o, 0, 2, 1, 3).reshape(B, S, D) @ wo

    def _B_ref(x, w1, w2, w3, w4):
        B, S, D = x.shape
        h = _gelu(_layernorm(x, axis=-1) @ w1)
        c = D // 4
        g0 = _pad(h[:, :, 0 * c:1 * c], ((0, 0), (1, 0), (0, 0)))[:, :S, :]
        g1 = _pad(h[:, :, 1 * c:2 * c], ((0, 0), (0, 1), (0, 0)))[:, 1:, :]
        g2 = _pad(h[:, :, 2 * c:3 * c], ((0, 0), (2, 0), (0, 0)))[:, :S, :]
        g3 = _pad(h[:, :, 3 * c:], ((0, 0), (0, 2), (0, 0)))[:, 2:, :]
        hs = torch.concatenate([g0, g1, g2, g3], axis=-1) @ w2
        x1 = x + hs
        h2 = _gelu(_layernorm(x1, axis=-1) @ w3) @ w4
        return x1 + h2
    x = A_x
    mod = (_silu(c) @ w_mod).reshape(c.shape[0], 6, 1, -1)
    sa, ca, ga, sb, cb, gb = (mod[:, 0].clone(), mod[:, 1].clone(), mod[:, 2].clone(), mod[:, 3].clone(), mod[:, 4].clone(), mod[:, 5].clone())
    h = _layernorm(x, axis=-1) * (1 + ca) + sa
    x = x + ga * _A_ref(h, A_wqkv, A_wo)
    h = _layernorm(x, axis=-1) * (1 + cb) + sb
    x = x + gb * _B_ref(h, B_w1, B_w2, B_w3, B_w4)
    return x
```

```asm
; @launch grid=(256,1,1) block=(512,1,1) lds=163840
.amdgcn_target "amdgcn-amd-amdhsa--gfx950"
.text
.globl adaLN_cond__sliding_local_dilated__mixer_s_mlp__prompt_kernel
.p2align 8
.type adaLN_cond__sliding_local_dilated__mixer_s_mlp__prompt_kernel,@function
adaLN_cond__sliding_local_dilated__mixer_s_mlp__prompt_kernel:
    s_load_dwordx16 s[8:23], s[0:1], 0
    s_load_dwordx8 s[24:31], s[0:1], 64
    s_load_dwordx2 s[32:33], s[0:1], 96
    s_cmp_ge_u32 s2, 256
    s_cbranch_scc1 L_exit
    v_lshrrev_b32 v1, 6, v0
    v_and_b32 v0, 63, v0
    v_readfirstlane_b32 s3, v1
    s_getreg_b32 s60, hwreg(HW_REG_XCC_ID)
    s_lshr_b32 s4, s2, 3
    s_and_b32 s53, s4, 7
    s_cmp_lg_u32 s3, 7
    s_cbranch_scc1 L_nopf
    s_getpc_b64 s[48:49]
L_pc:
    s_mov_b32 s50, L_codeend-L_pc
    s_mov_b32 s51, 0x20000
    s_lshl_b32 s5, s53, 13
    v_lshlrev_b32 v1, 7, v0
    buffer_load_dword v95, v1, s[48:51], s5 offen
L_nopf:
    s_lshr_b32 s55, s4, 3
    s_and_b32 s5, s2, 7
    s_lshl_b32 s5, s5, 2
    s_add_u32 s54, s5, s55
    s_add_u32 s58, s54, 1
    s_lshl_b32 s58, s58, 20
    s_add_u32 s93, s58, 0x90000
    s_and_b32 s52, s3, 3
    s_mul_i32 s61, s52, 3072
    s_lshl_b32 s62, s52, 12
    s_lshl_b32 s90, s53, 2
    s_add_u32 s90, s90, s52
    s_lshl_b32 s90, s90, 1
    s_cmp_eq_u32 s53, 3
    s_cselect_b32 s6, s55, 0
    s_mul_i32 s4, s6, 0
    s_mul_i32 s6, s6, 0
    s_mov_b32 s5, 0
    s_and_b32 s7, s4, 8
    s_mov_b32 s59, 200000
    s_mov_b32 s57, 0
    v_lshlrev_b32 v1, 2, v0
    v_add_u32 v1, 161792, v1
    v_mov_b32 v2, 0
    ds_write_b32 v1, v2
    s_cmp_ge_u32 s3, 4
    s_cbranch_scc1 L_teamB
    s_setprio 3
    v_mov_b32 v61, 161792
    s_lshl_b32 s64, s52, 2
    v_add_u32 v60, s64, v61
    v_and_b32 v1, 15, v0
    v_lshrrev_b32 v2, 4, v0
    s_lshl_b32 s64, s53, 6
    s_lshl_b32 s65, s52, 4
    s_add_u32 s64, s64, s65
    v_lshl_add_u32 v3, v2, 2, s64
    v_lshlrev_b32 v5, 1, v3
    v_mul_u32_u24 v3, 6144, v3
    s_mul_i32 s64, s54, 192
    v_lshlrev_b32 v4, 4, v1
    v_add3_u32 v3, v3, v4, s64
    v_cmp_gt_u32 vcc, 12, v1
    v_mov_b32 v4, 0x80000000
    s_nop 0
    v_cndmask_b32_e64 v3, v4, v3, vcc
    s_mov_b32 s65, 6144
    s_mov_b32 s66, 12288
    s_mov_b32 s67, 18432
    s_waitcnt lgkmcnt(0)
    s_mov_b32 s40, s32
    s_mov_b32 s41, s33
    s_mov_b32 s42, 0x2300000
    s_mov_b32 s43, 0x20000
    v_mov_b32 v30, 16384
    buffer_load_dword v30, v30, s[40:43], 0 offen
    s_mov_b32 s44, s26
    s_mov_b32 s45, s27
    s_mov_b32 s46, 0x300000
    s_mov_b32 s47, 0x20000
    s_mov_b32 s48, s24
    s_mov_b32 s49, s25
    s_mov_b32 s50, 0x400
    s_mov_b32 s51, 0x20000
    buffer_load_dwordx2 v[6:7], v5, s[48:51], 0 offen
    buffer_load_dwordx4 v[8:11], v3, s[44:47], 0 offen nt
    buffer_load_dwordx4 v[12:15], v3, s[44:47], s65 offen nt
    buffer_load_dwordx4 v[16:19], v3, s[44:47], s66 offen nt
    buffer_load_dwordx4 v[20:23], v3, s[44:47], s67 offen nt
    s_barrier
    s_branch L_teamA2
L_teamB:
    s_setprio 2
    v_lshrrev_b32 v16, 3, v0
    v_and_b32 v17, 7, v0
    s_lshl_b32 s64, s54, 3
    s_add_u32 s64, s64, s53
    s_lshl_b32 s64, s64, 13
    s_lshl_b32 s65, s52, 8
    v_lshlrev_b32 v19, 4, v17
    v_add_u32 v19, s65, v19
    v_lshl_add_u32 v2, v16, 10, v19
    v_add_u32 v2, s64, v2
    s_cmp_lt_u32 s53, 2
    s_mov_b32 s65, 0x80000000
    s_cselect_b32 s65, 0xffffc000, s65
    v_add_u32 v5, s65, v2
    s_lshl_b32 s70, s2, 2
    s_add_u32 s70, s70, s52
    s_mul_i32 s70, s70, 12
    v_min_u32 v7, 11, v0
    v_add_u32 v7, s70, v7
    v_lshlrev_b32 v7, 7, v7
    s_lshr_b32 s70, s2, 3
    s_lshl_b32 s70, s70, 2
    s_add_u32 s70, s70, s52
    s_mul_i32 s70, s70, 12
    v_and_b32 v18, 31, v0
    v_min_u32 v18, 11, v18
    v_add_u32 v18, s70, v18
    v_lshlrev_b32 v18, 10, v18
    v_add_u32 v18, 384, v18
    v_cmp_gt_u32 vcc, 32, v0
    s_nop 1
    v_cndmask_b32_e64 v7, v18, v7, vcc
    s_waitcnt lgkmcnt(0)
    s_mov_b32 s40, s32
    s_mov_b32 s41, s33
    s_mov_b32 s42, 0x2300000
    s_mov_b32 s43, 0x20000
    v_mov_b32 v30, 16384
    buffer_load_dword v30, v30, s[40:43], 0 offen
    s_mov_b32 s44, s8
    s_mov_b32 s45, s9
    s_mov_b32 s46, 0x200000
    s_mov_b32 s47, 0x20000
    s_mov_b32 s48, s10
    s_mov_b32 s49, s11
    s_mov_b32 s50, 0x180000
    s_mov_b32 s51, 0x20000
    s_barrier
    buffer_load_dwordx4 v[128:131], v2, s[44:47], 0 offen offset:0 nt
    buffer_load_dwordx4 v[132:135], v2, s[44:47], 0 offen offset:128 nt
    buffer_load_dwordx4 v[136:139], v5, s[44:47], 0 offen offset:0 nt
    buffer_load_dwordx4 v[140:143], v5, s[44:47], 0 offen offset:128 nt
    buffer_load_dword v94, v7, s[48:51], 0 offen
    s_branch L_teamB2
L_wf_4r:
    s_sleep 1
    s_sub_u32 s59, s59, 1
    s_cbranch_scc0 L_wf_4
    s_mov_b32 s59, 0
    s_branch L_wf_4y
L_wf_5r:
    s_sleep 1
    s_sub_u32 s59, s59, 1
    s_cbranch_scc0 L_wf_5
    s_mov_b32 s59, 0
    s_branch L_wf_5y
L_wf_6r:
    s_sleep 1
    s_sub_u32 s59, s59, 1
    s_cbranch_scc0 L_wf_6
    s_mov_b32 s59, 0
    s_branch L_wf_6y
L_wf_7r:
    s_sleep 1
    s_sub_u32 s59, s59, 1
    s_cbranch_scc0 L_wf_7
    s_mov_b32 s59, 0
    s_branch L_wf_7y
L_wf_8r:
    s_sleep 1
    s_sub_u32 s59, s59, 1
    s_cbranch_scc0 L_wf_8
    s_mov_b32 s59, 0
    s_branch L_wf_8y
L_wf_9r:
    s_sleep 1
    s_sub_u32 s59, s59, 1
    s_cbranch_scc0 L_wf_9
    s_mov_b32 s59, 0
    s_branch L_wf_9y
L_wf_10r:
    s_sleep 1
    s_sub_u32 s59, s59, 1
    s_cbranch_scc0 L_wf_10
    s_mov_b32 s59, 0
    s_branch L_wf_10y
L_wf_11r:
    s_sleep 1
    s_sub_u32 s59, s59, 1
    s_cbranch_scc0 L_wf_11
    s_mov_b32 s59, 0
    s_branch L_wf_11y
L_wf_1001r:
    s_sleep 1
    s_sub_u32 s59, s59, 1
    s_cbranch_scc0 L_wf_1001
    s_mov_b32 s59, 0
    s_branch L_wf_1001y
L_wf_1002r:
    s_sleep 1
    s_sub_u32 s59, s59, 1
    s_cbranch_scc0 L_wf_1002
    s_mov_b32 s59, 0
    s_branch L_wf_1002y
L_wf_1006r:
    s_sleep 1
    s_sub_u32 s59, s59, 1
    s_cbranch_scc0 L_wf_1006
    s_mov_b32 s59, 0
    s_branch L_wf_1006y
L_teamA2:
    v_min_u32 v4, 4, v0
    v_lshlrev_b32 v4, 7, v4
    buffer_load_dword v62, v4, s[40:43], s93 offen sc1
    s_mov_b32 s36, s10
    s_mov_b32 s37, s11
    s_mov_b32 s38, 0x180000
    s_mov_b32 s39, 0x20000
    s_lshl_b32 s71, s53, 7
    s_mul_i32 s63, s4, 98304
    v_lshrrev_b32 v4, 3, v0
    s_lshl_b32 s64, s52, 3
    v_add_u32 v4, s64, v4
    v_mul_u32_u24 v52, 3072, v4
    v_bfe_u32 v4, v0, 4, 1
    s_and_b32 s64, s52, 1
    s_lshl_b32 s64, s64, 1
    v_or_b32 v4, s64, v4
    v_lshlrev_b32 v4, 1, v4
    v_xor_b32 v4, v4, v0
    v_and_b32 v4, 7, v4
    v_lshlrev_b32 v4, 4, v4
    v_add3_u32 v52, v52, v4, s71
    v_lshl_add_u32 v3, v1, 2, v2
    v_mul_u32_u24 v4, 43, v3
    v_lshrrev_b32 v4, 8, v4
    v_mul_u32_u24 v5, 6, v4
    v_sub_u32 v3, v3, v5
    v_lshlrev_b32 v3, 4, v3
    v_lshl_add_u32 v3, v4, 12, v3
    v_cmp_gt_u32 vcc, 12, v1
    v_lshl_add_u32 v4, v1, 2, v2
    v_subrev_u32 v4, 48, v4
    v_lshrrev_b32 v5, 1, v4
    v_and_b32 v4, 1, v4
    v_lshlrev_b32 v4, 4, v4
    v_lshl_add_u32 v4, v5, 12, v4
    v_add_u32 v4, 96, v4
    v_cndmask_b32_e64 v48, v4, v3, vcc
    s_lshl_b32 s68, s53, 2
    s_add_u32 s68, s68, s52
    s_lshl_b32 s68, s68, 7
    s_add_u32 s68, s68, s58
    s_add_u32 s68, s68, 0x24000
    v_lshrrev_b32 v4, 4, v0
    v_mul_u32_u24 v53, 3072, v4
    v_bfe_u32 v4, v0, 3, 2
    v_xor_b32 v4, s52, v4
    v_lshl_add_u32 v53, v4, 5, v53
    v_bfe_u32 v4, v0, 2, 2
    v_lshl_add_u32 v53, v4, 7, v53
    v_and_b32 v4, 3, v0
    v_lshl_add_u32 v53, v4, 3, v53
    v_add_u32 v54, 0x10000, v53
    v_add_u32 v55, 0x20000, v53
    s_waitcnt vmcnt(1)
    v_readfirstlane_b32 s56, v30
    s_nop 1
    s_mul_i32 s56, s56, 1664525
    s_add_u32 s56, s56, 1013904223
    v_lshlrev_b32 v24, 16, v6
    v_and_b32 v25, 0xffff0000, v6
    v_lshlrev_b32 v26, 16, v7
    v_and_b32 v27, 0xffff0000, v7
    v_mul_f32 v28, 0xbfb8aa3b, v24
    v_mul_f32 v29, 0xbfb8aa3b, v25
    v_mul_f32 v30, 0xbfb8aa3b, v26
    v_mul_f32 v31, 0xbfb8aa3b, v27
    v_exp_f32 v28, v28
    v_exp_f32 v29, v29
    v_exp_f32 v30, v30
    v_exp_f32 v31, v31
    v_add_f32 v28, 1.0, v28
    v_add_f32 v29, 1.0, v29
    v_add_f32 v30, 1.0, v30
    v_add_f32 v31, 1.0, v31
    v_rcp_f32 v28, v28
    v_rcp_f32 v29, v29
    v_rcp_f32 v30, v30
    v_rcp_f32 v31, v31
    v_mul_f32 v24, v24, v28
    v_mul_f32 v25, v25, v29
    v_mul_f32 v26, v26, v30
    v_mul_f32 v27, v27, v31
    v_cvt_pk_bf16_f32 v6, v24, v25
    v_cvt_pk_bf16_f32 v7, v26, v27
    v_lshlrev_b32 v24, 16, v6
    v_and_b32 v25, 0xffff0000, v6
    v_lshlrev_b32 v26, 16, v7
    v_and_b32 v27, 0xffff0000, v7
    v_lshlrev_b32 v40, 16, v8
    v_and_b32 v41, 0xffff0000, v8
    v_lshlrev_b32 v42, 16, v9
    v_and_b32 v43, 0xffff0000, v9
    v_lshlrev_b32 v44, 16, v10
    v_and_b32 v45, 0xffff0000, v10
    v_lshlrev_b32 v46, 16, v11
    v_and_b32 v47, 0xffff0000, v11
    v_pk_mul_f32 v[32:33], v[40:41], v[24:25] op_sel:[0,0] op_sel_hi:[1,0]
    v_pk_mul_f32 v[34:35], v[42:43], v[24:25] op_sel:[0,0] op_sel_hi:[1,0]
    v_pk_mul_f32 v[36:37], v[44:45], v[24:25] op_sel:[0,0] op_sel_hi:[1,0]
    v_pk_mul_f32 v[38:39], v[46:47], v[24:25] op_sel:[0,0] op_sel_hi:[1,0]
    v_lshlrev_b32 v40, 16, v12
    v_and_b32 v41, 0xffff0000, v12
    v_lshlrev_b32 v42, 16, v13
    v_and_b32 v43, 0xffff0000, v13
    v_lshlrev_b32 v44, 16, v14
    v_and_b32 v45, 0xffff0000, v14
    v_lshlrev_b32 v46, 16, v15
    v_and_b32 v47, 0xffff0000, v15
    v_pk_fma_f32 v[32:33], v[40:41], v[24:25], v[32:33] op_sel:[0,1,0] op_sel_hi:[1,1,1]
    v_pk_fma_f32 v[34:35], v[42:43], v[24:25], v[34:35] op_sel:[0,1,0] op_sel_hi:[1,1,1]
    v_pk_fma_f32 v[36:37], v[44:45], v[24:25], v[36:37] op_sel:[0,1,0] op_sel_hi:[1,1,1]
    v_pk_fma_f32 v[38:39], v[46:47], v[24:25], v[38:39] op_sel:[0,1,0] op_sel_hi:[1,1,1]
    v_lshlrev_b32 v40, 16, v16
    v_and_b32 v41, 0xffff0000, v16
    v_lshlrev_b32 v42, 16, v17
    v_and_b32 v43, 0xffff0000, v17
    v_lshlrev_b32 v44, 16, v18
    v_and_b32 v45, 0xffff0000, v18
    v_lshlrev_b32 v46, 16, v19
    v_and_b32 v47, 0xffff0000, v19
    v_pk_fma_f32 v[32:33], v[40:41], v[26:27], v[32:33] op_sel:[0,0,0] op_sel_hi:[1,0,1]
    v_pk_fma_f32 v[34:35], v[42:43], v[26:27], v[34:35] op_sel:[0,0,0] op_sel_hi:[1,0,1]
    v_pk_fma_f32 v[36:37], v[44:45], v[26:27], v[36:37] op_sel:[0,0,0] op_sel_hi:[1,0,1]
    v_pk_fma_f32 v[38:39], v[46:47], v[26:27], v[38:39] op_sel:[0,0,0] op_sel_hi:[1,0,1]
    v_lshlrev_b32 v40, 16, v20
    v_and_b32 v41, 0xffff0000, v20
    v_lshlrev_b32 v42, 16, v21
    v_and_b32 v43, 0xffff0000, v21
    v_lshlrev_b32 v44, 16, v22
    v_and_b32 v45, 0xffff0000, v22
    v_lshlrev_b32 v46, 16, v23
    v_and_b32 v47, 0xffff0000, v23
    v_pk_fma_f32 v[32:33], v[40:41], v[26:27], v[32:33] op_sel:[0,1,0] op_sel_hi:[1,1,1]
    v_pk_fma_f32 v[34:35], v[42:43], v[26:27], v[34:35] op_sel:[0,1,0] op_sel_hi:[1,1,1]
    v_pk_fma_f32 v[36:37], v[44:45], v[26:27], v[36:37] op_sel:[0,1,0] op_sel_hi:[1,1,1]
    v_pk_fma_f32 v[38:39], v[46:47], v[26:27], v[38:39] op_sel:[0,1,0] op_sel_hi:[1,1,1]
    s_nop 0
    v_permlane32_swap_b32 v32, v36
    v_permlane32_swap_b32 v34, v38
    v_permlane32_swap_b32 v33, v37
    v_permlane32_swap_b32 v35, v39
    v_add_f32 v32, v32, v36
    v_add_f32 v34, v34, v38
    v_add_f32 v33, v33, v37
    v_add_f32 v35, v35, v39
    v_permlane16_swap_b32 v32, v34
    s_nop 0
    v_permlane16_swap_b32 v33, v35
    v_add_f32 v32, v32, v34
    v_add_f32 v33, v33, v35
    v_mov_b32 v34, s56
    v_mov_b32 v35, s60
    buffer_store_dwordx4 v[32:35], v48, s[40:43], s68 offen sc1
    s_setprio 1
    s_setprio 0
    s_lshl_b32 s69, s53, 12
    s_add_u32 s69, s69, s58
    s_add_u32 s69, s69, 0x24000
    s_cmp_eq_u32 s52, 0
    s_cselect_b32 s69, s69, 0x80000000
    s_mov_b32 s78, 0x3f3f3f3f
    s_mov_b32 s79, 0x3f3f3f3f
    v_lshlrev_b32 v10, 4, v0
    s_lshl_b32 s64, s54, 3
    s_add_u32 s64, s64, s53
    s_mul_i32 s64, s64, 6
    v_add_u32 v4, s64, v0
    v_lshrrev_b32 v5, 8, v4
    v_lshrrev_b32 v9, v5, 18
    v_and_b32 v9, 1, v9
    v_cvt_f32_u32 v9, v9
    v_lshlrev_b32 v15, 11, v5
    v_bfe_u32 v5, v4, 2, 6
    v_lshl_add_u32 v15, v5, 4, v15
    v_bfe_u32 v5, v4, 1, 1
    v_lshl_add_u32 v15, v5, 10, v15
    v_and_b32 v5, 1, v4
    v_lshl_add_u32 v15, v5, 3, v15
    v_mov_b32 v5, 0x80000000
    v_cmp_gt_u32 vcc, 6, v0
    s_nop 1
    v_cndmask_b32_e64 v15, v5, v15, vcc
    v_and_b32 v4, 15, v0
    v_lshrrev_b32 v5, 4, v0
    v_and_b32 v6, 1, v0
    v_cmp_eq_u32 s[72:73], 1, v6
    v_lshl_add_u32 v7, v5, 2, v6
    v_cmp_le_u32 s[74:75], v7, v4
    v_add_u32 v7, 2, v7
    v_cmp_le_u32 s[76:77], v7, v4
    v_mov_b32 v8, 0x0c0c0100
    v_mov_b32 v13, 0x01000c0c
    v_mov_b32 v14, 0x0c0c0302
    v_mov_b32 v11, 0x03020c0c
    v_mov_b32 v12, 0x0c0c0c0c
    v_cndmask_b32 v8, v8, v13, s[72:73]
    v_cndmask_b32 v14, v14, v11, s[72:73]
    v_cndmask_b32 v46, v12, v8, s[74:75]
    v_cndmask_b32 v47, v12, v14, s[76:77]
    v_cndmask_b32 v48, v8, v12, s[74:75]
    v_cndmask_b32 v49, v14, v12, s[76:77]
    v_lshlrev_b32 v1, 4, v0
    s_cmp_eq_u32 s54, 0
    s_cselect_b32 s84, 0xf149f2ca, 0
    s_mov_b32 s94, 0x3eb8aa3b
    s_and_b32 s64, s90, 3
    s_lshl_b32 s64, s64, 2
    s_bfe_u32 s65, s90, 0x20002
    s_or_b32 s64, s64, s65
    s_andn2_b32 s34, s90, 15
    s_or_b32 s34, s34, s64
    v_lshrrev_b32 v4, 5, v0
    v_lshlrev_b32 v4, 12, v4
    v_and_b32 v3, 31, v0
    v_lshl_add_u32 v3, v3, 4, v4
    s_lshl_b32 s64, s34, 10
    v_add_u32 v3, s64, v3
    s_add_u32 s64, s4, s52
    s_add_u32 s64, s64, 0
    s_and_b32 s64, s64, 15
    s_lshl_b32 s64, s64, 12
    s_add_u32 s64, s64, s58
    s_add_u32 s80, s64, 0x0
    s_add_u32 s64, s4, s52
    s_add_u32 s64, s64, 4
    s_and_b32 s64, s64, 15
    s_lshl_b32 s64, s64, 12
    s_add_u32 s64, s64, s58
    s_add_u32 s81, s64, 0x0
    s_add_u32 s64, s4, s52
    s_add_u32 s64, s64, 8
    s_and_b32 s64, s64, 15
    s_lshl_b32 s64, s64, 12
    s_add_u32 s64, s64, s58
    s_add_u32 s82, s64, 0x0
    s_add_u32 s64, s4, s52
    s_add_u32 s64, s64, 12
    s_and_b32 s64, s64, 15
    s_lshl_b32 s64, s64, 12
    s_add_u32 s64, s64, s58
    s_add_u32 s83, s64, 0x0
    v_lshrrev_b32 v4, 3, v0
    v_lshlrev_b32 v40, 10, v4
    v_and_b32 v4, 2, v4
    v_xor_b32 v4, v4, v0
    v_and_b32 v4, 7, v4
    v_lshl_add_u32 v40, v4, 4, v40
    s_lshl_b32 s64, s53, 7
    v_add_u32 v40, s64, v40
    v_xor_b32 v41, 64, v40
    v_add_u32 v42, 14336, v40
    v_add_u32 v43, 21504, v41
    v_add_u32 v41, 7168, v41
    v_lshrrev_b32 v4, 4, v0
    v_mul_u32_u24 v44, 1024, v4
    v_bfe_u32 v4, v0, 3, 2
    v_xor_b32 v4, s52, v4
    v_lshl_add_u32 v44, v4, 5, v44
    v_bfe_u32 v4, v0, 2, 2
    v_lshl_add_u32 v44, v4, 7, v44
    v_and_b32 v4, 3, v0
    v_lshl_add_u32 v44, v4, 3, v44
    v_add_u32 v44, 81920, v44
    v_lshrrev_b32 v4, 4, v0
    v_mul_u32_u24 v45, 3072, v4
    v_bfe_u32 v4, v0, 3, 2
    v_xor_b32 v4, s52, v4
    v_lshl_add_u32 v45, v4, 5, v45
    v_bfe_u32 v4, v0, 2, 2
    v_mul_u32_u24 v4, 384, v4
    v_add_u32 v45, v45, v4
    v_and_b32 v4, 3, v0
    v_lshl_add_u32 v45, v4, 3, v45
    v_add_u32 v45, 65536, v45
    s_waitcnt vmcnt(0)
    s_setprio 2
    buffer_load_dwordx4 v[16:19], v10, s[40:43], s69 offen offset:0 sc1
    buffer_load_dwordx4 v[20:23], v10, s[40:43], s69 offen offset:1024 sc1
    buffer_load_dwordx4 v[24:27], v10, s[40:43], s69 offen offset:2048 sc1
    buffer_load_dwordx4 v[28:31], v10, s[40:43], s69 offen offset:3072 sc1
    s_add_u32 m0, s61, 45056
    s_nop 0
    buffer_load_dwordx4 v52, s[36:39], s63 offen offset:0 lds
    buffer_load_dwordx4 v52, s[36:39], s63 offen offset:1024 lds
    buffer_load_dwordx4 v52, s[36:39], s63 offen offset:2048 lds
    s_add_u32 s63, s63, 98304
    s_cmp_ge_u32 s63, 1572864
    s_cselect_b32 s63, 0, s63
    s_add_u32 m0, s61, 57344
    s_nop 0
    buffer_load_dwordx4 v52, s[36:39], s63 offen offset:0 lds
    buffer_load_dwordx4 v52, s[36:39], s63 offen offset:1024 lds
    buffer_load_dwordx4 v52, s[36:39], s63 offen offset:2048 lds
    s_add_u32 s63, s63, 98304
    s_cmp_ge_u32 s63, 1572864
    s_cselect_b32 s63, 0, s63
    s_add_u32 m0, s61, 69632
    s_nop 0
    buffer_load_dwordx4 v52, s[36:39], s63 offen offset:0 lds
    buffer_load_dwordx4 v52, s[36:39], s63 offen offset:1024 lds
    buffer_load_dwordx4 v52, s[36:39], s63 offen offset:2048 lds
    s_add_u32 s63, s63, 98304
    s_cmp_ge_u32 s63, 1572864
    s_cselect_b32 s63, 0, s63
    s_waitcnt vmcnt(9)
    s_cmp_lg_u32 s52, 0
    s_cbranch_scc1 L_m2_1
L_pl_2c:
    v_xor_b32 v5, s56, v18
    v_xor_b32 v6, s56, v22
    v_xor_b32 v7, s56, v26
    v_xor_b32 v8, s56, v30
    v_or3_b32 v5, v5, v6, v7
    v_or_b32 v5, v5, v8
    v_cmp_ne_u32 vcc, 0, v5
    s_nop 1
    s_and_b64 vcc, vcc, s[78:79]
    s_cbranch_vccnz L_pl_2r
L_pl_2y:
    v_pk_add_f32 v[16:17], v[16:17], v[20:21]
    v_pk_add_f32 v[24:25], v[24:25], v[28:29]
    v_xor_b32 v5, s60, v19
    v_pk_add_f32 v[16:17], v[16:17], v[24:25]
    v_xor_b32 v6, s60, v23
    v_xor_b32 v7, s60, v27
    v_add_f32_dpp v16, v16, v16 row_ror:8 row_mask:0xf bank_mask:0xf
    v_add_f32_dpp v17, v17, v17 row_ror:8 row_mask:0xf bank_mask:0xf
    v_xor_b32 v8, s60, v31
    v_or3_b32 v5, v5, v6, v7
    v_mov_b32 v20, v16
    v_mov_b32 v21, v17
    s_nop 0
    v_permlane32_swap_b32 v16, v20
    v_permlane32_swap_b32 v17, v21
    v_add_f32 v16, v16, v20
    v_add_f32 v17, v17, v21
    v_mov_b32 v20, v16
    v_mov_b32 v21, v17
    s_nop 0
    v_permlane16_swap_b32 v16, v20
    v_permlane16_swap_b32 v17, v21
    v_add_f32 v16, v16, v20
    v_add_f32 v17, v17, v21
    v_cvt_pk_bf16_f32 v16, v16, v17
    v_and_b32 v17, 0xffff0000, v16
    v_lshlrev_b32 v16, 16, v16
    v_add_f32 v16, v16, v9
    v_add_f32 v17, v17, v9
    v_cvt_pk_bf16_f32 v16, v16, v17
    v_mov_b32 v17, s56
    buffer_store_dwordx2 v[16:17], v15, s[40:43], 0 offen sc1
    v_or_b32 v5, v5, v8
    v_cmp_ne_u32 vcc, 0, v5
    s_nop 1
    s_and_b64 vcc, vcc, s[78:79]
    s_cselect_b32 s65, 0, 1
    v_mov_b32 v5, s65
    v_mov_b32 v6, 161824
    ds_write_b32 v6, v5
L_m2_1:
    s_waitcnt vmcnt(6)
    s_add_u32 m0, s61, 81920
    s_nop 0
    buffer_load_dwordx4 v52, s[36:39], s63 offen offset:0 lds
    buffer_load_dwordx4 v52, s[36:39], s63 offen offset:1024 lds
    buffer_load_dwordx4 v52, s[36:39], s63 offen offset:2048 lds
    s_add_u32 s63, s63, 98304
    s_cmp_ge_u32 s63, 1572864
    s_cselect_b32 s63, 0, s63
    s_cmp_eq_u32 s52, 0
    s_cselect_b64 s[44:45], s[12:13], s[16:17]
    s_cmp_eq_u32 s52, 1
    s_cselect_b64 s[44:45], s[18:19], s[44:45]
    s_mov_b32 s46, 0x80000
    s_mul_i32 s70, s2, 16
    v_min_u32 v4, 15, v0
    v_add_u32 v4, s70, v4
    v_lshlrev_b32 v4, 7, v4
    s_lshr_b32 s70, s2, 3
    s_mul_i32 s70, s70, 16
    v_and_b32 v5, 31, v0
    v_min_u32 v5, 15, v5
    v_add_u32 v5, s70, v5
    v_lshlrev_b32 v5, 10, v5
    v_add_u32 v5, 384, v5
    v_cmp_gt_u32 vcc, 32, v0
    s_nop 1
    v_cndmask_b32_e64 v4, v5, v4, vcc
    buffer_load_dword v62, v4, s[44:47], 0 offen
    s_getpc_b64 s[48:49]
L_ct_3:
    s_sub_u32 s48, s48, L_ct_3-L_pc
    s_subb_u32 s49, s49, 0
    s_mov_b32 s50, L_codeend-L_pc
    s_mov_b32 s51, 0x20000
    s_lshr_b32 s95, s2, 3
    s_lshl_b32 s95, s95, 2
    s_add_u32 s95, s95, s52
    s_lshl_b32 s95, s95, 9
    v_min_u32 v4, 3, v0
    v_lshlrev_b32 v4, 7, v4
    buffer_load_dword v62, v4, s[48:51], s95 offen
    s_waitcnt vmcnt(8)
    s_add_u32 m0, s61, 94208
    s_nop 0
    buffer_load_dwordx4 v52, s[36:39], s63 offen offset:0 lds
    buffer_load_dwordx4 v52, s[36:39], s63 offen offset:1024 lds
    buffer_load_dwordx4 v52, s[36:39], s63 offen offset:2048 lds
    s_add_u32 s63, s63, 98304
    s_cmp_ge_u32 s63, 1572864
    s_cselect_b32 s63, 0, s63
    s_waitcnt lgkmcnt(0)
    v_mov_b32 v56, 1
    ds_write_b32 v60, v56
    s_waitcnt vmcnt(8)
L_wf_4:
    ds_read_b128 v[56:59], v61
    s_waitcnt lgkmcnt(0)
    v_min3_u32 v56, v56, v57, v58
    v_min_u32 v56, v56, v59
    v_cmp_gt_u32 vcc, 1, v56
    s_cbranch_vccnz L_wf_4r
L_wf_4y:
    s_add_u32 m0, s61, 106496
    s_nop 0
    buffer_load_dwordx4 v52, s[36:39], s63 offen offset:0 lds
    buffer_load_dwordx4 v52, s[36:39], s63 offen offset:1024 lds
    buffer_load_dwordx4 v52, s[36:39], s63 offen offset:2048 lds
    s_add_u32 s63, s63, 98304
    s_cmp_ge_u32 s63, 1572864
    s_cselect_b32 s63, 0, s63
    ds_read_b64_tr_b16 v[64:65], v53 offset:45056
    ds_read_b64_tr_b16 v[66:67], v53 offset:45568
    ds_read_b64_tr_b16 v[68:69], v53 offset:46080
    ds_read_b64_tr_b16 v[70:71], v53 offset:46592
    ds_read_b64_tr_b16 v[72:73], v53 offset:47104
    ds_read_b64_tr_b16 v[74:75], v53 offset:47616
    ds_read_b64_tr_b16 v[76:77], v53 offset:57344
    ds_read_b64_tr_b16 v[78:79], v53 offset:57856
    ds_read_b64_tr_b16 v[80:81], v53 offset:58368
    ds_read_b64_tr_b16 v[82:83], v53 offset:58880
    ds_read_b64_tr_b16 v[84:85], v53 offset:59392
    ds_read_b64_tr_b16 v[86:87], v53 offset:59904
    s_waitcnt vmcnt(8)
    s_add_u32 m0, s61, 118784
    s_nop 0
    buffer_load_dwordx4 v52, s[36:39], s63 offen offset:0 lds
    buffer_load_dwordx4 v52, s[36:39], s63 offen offset:1024 lds
    buffer_load_dwordx4 v52, s[36:39], s63 offen offset:2048 lds
    s_add_u32 s63, s63, 98304
    s_cmp_ge_u32 s63, 1572864
    s_cselect_b32 s63, 0, s63
    s_waitcnt lgkmcnt(0)
    v_mov_b32 v56, 2
    ds_write_b32 v60, v56
    s_waitcnt vmcnt(6)
L_wf_5:
    ds_read_b128 v[56:59], v61
    s_waitcnt lgkmcnt(0)
    v_min3_u32 v56, v56, v57, v58
    v_min_u32 v56, v56, v59
    v_cmp_gt_u32 vcc, 2, v56
    s_cbranch_vccnz L_wf_5r
L_wf_5y:
    s_add_u32 m0, s61, 131072
    s_nop 0
    buffer_load_dwordx4 v52, s[36:39], s63 offen offset:0 lds
    buffer_load_dwordx4 v52, s[36:39], s63 offen offset:1024 lds
    buffer_load_dwordx4 v52, s[36:39], s63 offen offset:2048 lds
    s_add_u32 s63, s63, 98304
    s_cmp_ge_u32 s63, 1572864
    s_cselect_b32 s63, 0, s63
    ds_read_b64_tr_b16 v[88:89], v54 offset:4096
    ds_read_b64_tr_b16 v[90:91], v54 offset:4608
    ds_read_b64_tr_b16 v[92:93], v54 offset:5120
    ds_read_b64_tr_b16 v[94:95], v54 offset:5632
    ds_read_b64_tr_b16 v[96:97], v54 offset:6144
    ds_read_b64_tr_b16 v[98:99], v54 offset:6656
    ds_read_b64_tr_b16 v[100:101], v54 offset:16384
    ds_read_b64_tr_b16 v[102:103], v54 offset:16896
    ds_read_b64_tr_b16 v[104:105], v54 offset:17408
    ds_read_b64_tr_b16 v[106:107], v54 offset:17920
    ds_read_b64_tr_b16 v[108:109], v54 offset:18432
    ds_read_b64_tr_b16 v[110:111], v54 offset:18944
    s_waitcnt vmcnt(6)
    s_add_u32 m0, s61, 45056
    s_nop 0
    buffer_load_dwordx4 v52, s[36:39], s63 offen offset:0 lds
    buffer_load_dwordx4 v52, s[36:39], s63 offen offset:1024 lds
    buffer_load_dwordx4 v52, s[36:39], s63 offen offset:2048 lds
    s_add_u32 s63, s63, 98304
    s_cmp_ge_u32 s63, 1572864
    s_cselect_b32 s63, 0, s63
    s_waitcnt lgkmcnt(0)
    v_mov_b32 v56, 3
    ds_write_b32 v60, v56
    s_waitcnt vmcnt(6)
L_wf_6:
    ds_read_b128 v[56:59], v61
    s_waitcnt lgkmcnt(0)
    v_min3_u32 v56, v56, v57, v58
    v_min_u32 v56, v56, v59
    v_cmp_gt_u32 vcc, 3, v56
    s_cbranch_vccnz L_wf_6r
L_wf_6y:
    s_add_u32 m0, s61, 57344
    s_nop 0
    buffer_load_dwordx4 v52, s[36:39], s63 offen offset:0 lds
    buffer_load_dwordx4 v52, s[36:39], s63 offen offset:1024 lds
    buffer_load_dwordx4 v52, s[36:39], s63 offen offset:2048 lds
    s_add_u32 s63, s63, 98304
    s_cmp_ge_u32 s63, 1572864
    s_cselect_b32 s63, 0, s63
    ds_read_b64_tr_b16 v[112:113], v54 offset:28672
    ds_read_b64_tr_b16 v[114:115], v54 offset:29184
    ds_read_b64_tr_b16 v[116:117], v54 offset:29696
    ds_read_b64_tr_b16 v[118:119], v54 offset:30208
    ds_read_b64_tr_b16 v[120:121], v54 offset:30720
    ds_read_b64_tr_b16 v[122:123], v54 offset:31232
    ds_read_b64_tr_b16 v[124:125], v54 offset:40960
    ds_read_b64_tr_b16 v[126:127], v54 offset:41472
    ds_read_b64_tr_b16 v[128:129], v54 offset:41984
    ds_read_b64_tr_b16 v[130:131], v54 offset:42496
    ds_read_b64_tr_b16 v[132:133], v54 offset:43008
    ds_read_b64_tr_b16 v[134:135], v54 offset:43520
    s_waitcnt vmcnt(6)
    s_add_u32 m0, s61, 69632
    s_nop 0
    buffer_load_dwordx4 v52, s[36:39], s63 offen offset:0 lds
    buffer_load_dwordx4 v52, s[36:39], s63 offen offset:1024 lds
    buffer_load_dwordx4 v52, s[36:39], s63 offen offset:2048 lds
    s_add_u32 s63, s63, 98304
    s_cmp_ge_u32 s63, 1572864
    s_cselect_b32 s63, 0, s63
    s_waitcnt lgkmcnt(0)
    v_mov_b32 v56, 4
    ds_write_b32 v60, v56
    s_waitcnt vmcnt(6)
L_wf_7:
    ds_read_b128 v[56:59], v61
    s_waitcnt lgkmcnt(0)
    v_min3_u32 v56, v56, v57, v58
    v_min_u32 v56, v56, v59
    v_cmp_gt_u32 vcc, 4, v56
    s_cbranch_vccnz L_wf_7r
L_wf_7y:
    s_add_u32 m0, s61, 81920
    s_nop 0
    buffer_load_dwordx4 v52, s[36:39], s63 offen offset:0 lds
    buffer_load_dwordx4 v52, s[36:39], s63 offen offset:1024 lds
    buffer_load_dwordx4 v52, s[36:39], s63 offen offset:2048 lds
    s_add_u32 s63, s63, 98304
    s_cmp_ge_u32 s63, 1572864
    s_cselect_b32 s63, 0, s63
    ds_read_b64_tr_b16 v[136:137], v54 offset:53248
    ds_read_b64_tr_b16 v[138:139], v54 offset:53760
    ds_read_b64_tr_b16 v[140:141], v54 offset:54272
    ds_read_b64_tr_b16 v[142:143], v54 offset:54784
    ds_read_b64_tr_b16 v[144:145], v54 offset:55296
    ds_read_b64_tr_b16 v[146:147], v54 offset:55808
    ds_read_b64_tr_b16 v[148:149], v55 offset:0
    ds_read_b64_tr_b16 v[150:151], v55 offset:512
    ds_read_b64_tr_b16 v[152:153], v55 offset:1024
    ds_read_b64_tr_b16 v[154:155], v55 offset:1536
    ds_read_b64_tr_b16 v[156:157], v55 offset:2048
    ds_read_b64_tr_b16 v[158:159], v55 offset:2560
    s_waitcnt vmcnt(6)
    s_add_u32 m0, s61, 94208
    s_nop 0
    buffer_load_dwordx4 v52, s[36:39], s63 offen offset:0 lds
    buffer_load_dwordx4 v52, s[36:39], s63 offen offset:1024 lds
    buffer_load_dwordx4 v52, s[36:39], s63 offen offset:2048 lds
    s_add_u32 s63, s63, 98304
    s_cmp_ge_u32 s63, 1572864
    s_cselect_b32 s63, 0, s63
    s_waitcnt lgkmcnt(0)
    v_mov_b32 v56, 5
    ds_write_b32 v60, v56
    s_waitcnt vmcnt(6)
L_wf_8:
    ds_read_b128 v[56:59], v61
    s_waitcnt lgkmcnt(0)
    v_min3_u32 v56, v56, v57, v58
    v_min_u32 v56, v56, v59
    v_cmp_gt_u32 vcc, 5, v56
    s_cbranch_vccnz L_wf_8r
L_wf_8y:
    s_add_u32 m0, s61, 106496
    s_nop 0
    buffer_load_dwordx4 v52, s[36:39], s63 offen offset:0 lds
    buffer_load_dwordx4 v52, s[36:39], s63 offen offset:1024 lds
    buffer_load_dwordx4 v52, s[36:39], s63 offen offset:2048 lds
    s_add_u32 s63, s63, 98304
    s_cmp_ge_u32 s63, 1572864
    s_cselect_b32 s63, 0, s63
    ds_read_b64_tr_b16 v[160:161], v53 offset:45056
    ds_read_b64_tr_b16 v[162:163], v53 offset:45568
    ds_read_b64_tr_b16 v[164:165], v53 offset:46080
    ds_read_b64_tr_b16 v[166:167], v53 offset:46592
    ds_read_b64_tr_b16 v[168:169], v53 offset:47104
    ds_read_b64_tr_b16 v[170:171], v53 offset:47616
    ds_read_b64_tr_b16 v[172:173], v53 offset:57344
    ds_read_b64_tr_b16 v[174:175], v53 offset:57856
    ds_read_b64_tr_b16 v[176:177], v53 offset:58368
    ds_read_b64_tr_b16 v[178:179], v53 offset:58880
    ds_read_b64_tr_b16 v[180:181], v53 offset:59392
    ds_read_b64_tr_b16 v[182:183], v53 offset:59904
    s_waitcnt vmcnt(6)
    s_add_u32 m0, s61, 118784
    s_nop 0
    buffer_load_dwordx4 v52, s[36:39], s63 offen offset:0 lds
    buffer_load_dwordx4 v52, s[36:39], s63 offen offset:1024 lds
    buffer_load_dwordx4 v52, s[36:39], s63 offen offset:2048 lds
    s_add_u32 s63, s63, 98304
    s_cmp_ge_u32 s63, 1572864
    s_cselect_b32 s63, 0, s63
    s_waitcnt lgkmcnt(0)
    v_mov_b32 v56, 6
    ds_write_b32 v60, v56
    s_waitcnt vmcnt(6)
L_wf_9:
    ds_read_b128 v[56:59], v61
    s_waitcnt lgkmcnt(0)
    v_min3_u32 v56, v56, v57, v58
    v_min_u32 v56, v56, v59
    v_cmp_gt_u32 vcc, 6, v56
    s_cbranch_vccnz L_wf_9r
L_wf_9y:
    s_add_u32 m0, s61, 131072
    s_nop 0
    buffer_load_dwordx4 v52, s[36:39], s63 offen offset:0 lds
    buffer_load_dwordx4 v52, s[36:39], s63 offen offset:1024 lds
    buffer_load_dwordx4 v52, s[36:39], s63 offen offset:2048 lds
    ds_read_b64_tr_b16 v[184:185], v54 offset:4096
    ds_read_b64_tr_b16 v[186:187], v54 offset:4608
    ds_read_b64_tr_b16 v[188:189], v54 offset:5120
    ds_read_b64_tr_b16 v[190:191], v54 offset:5632
    ds_read_b64_tr_b16 v[192:193], v54 offset:6144
    ds_read_b64_tr_b16 v[194:195], v54 offset:6656
    ds_read_b64_tr_b16 v[196:197], v54 offset:16384
    ds_read_b64_tr_b16 v[198:199], v54 offset:16896
    ds_read_b64_tr_b16 v[200:201], v54 offset:17408
    ds_read_b64_tr_b16 v[202:203], v54 offset:17920
    ds_read_b64_tr_b16 v[204:205], v54 offset:18432
    ds_read_b64_tr_b16 v[206:207], v54 offset:18944
    s_waitcnt vmcnt(6)
    s_waitcnt lgkmcnt(0)
    v_mov_b32 v56, 7
    ds_write_b32 v60, v56
    s_waitcnt vmcnt(3)
L_wf_10:
    ds_read_b128 v[56:59], v61
    s_waitcnt lgkmcnt(0)
    v_min3_u32 v56, v56, v57, v58
    v_min_u32 v56, v56, v59
    v_cmp_gt_u32 vcc, 7, v56
    s_cbranch_vccnz L_wf_10r
L_wf_10y:
    ds_read_b64_tr_b16 v[208:209], v54 offset:28672
    ds_read_b64_tr_b16 v[210:211], v54 offset:29184
    ds_read_b64_tr_b16 v[212:213], v54 offset:29696
    ds_read_b64_tr_b16 v[214:215], v54 offset:30208
    ds_read_b64_tr_b16 v[216:217], v54 offset:30720
    ds_read_b64_tr_b16 v[218:219], v54 offset:31232
    ds_read_b64_tr_b16 v[220:221], v54 offset:40960
    ds_read_b64_tr_b16 v[222:223], v54 offset:41472
    ds_read_b64_tr_b16 v[224:225], v54 offset:41984
    ds_read_b64_tr_b16 v[226:227], v54 offset:42496
    ds_read_b64_tr_b16 v[228:229], v54 offset:43008
    ds_read_b64_tr_b16 v[230:231], v54 offset:43520
    v_mov_b32 v4, 161824
    ds_read_b32 v4, v4
    s_waitcnt lgkmcnt(0)
    v_readfirstlane_b32 s57, v4
    s_waitcnt vmcnt(0)
    s_waitcnt lgkmcnt(0)
    v_mov_b32 v56, 8
    ds_write_b32 v60, v56
L_wf_11:
    ds_read_b128 v[56:59], v61
    s_waitcnt lgkmcnt(0)
    v_min3_u32 v56, v56, v57, v58
    v_min_u32 v56, v56, v59
    v_cmp_gt_u32 vcc, 8, v56
    s_cbranch_vccnz L_wf_11r
L_wf_11y:
    ds_read_b64_tr_b16 v[232:233], v54 offset:53248
    ds_read_b64_tr_b16 v[234:235], v54 offset:53760
    ds_read_b64_tr_b16 v[236:237], v54 offset:54272
    ds_read_b64_tr_b16 v[238:239], v54 offset:54784
    ds_read_b64_tr_b16 v[240:241], v54 offset:55296
    ds_read_b64_tr_b16 v[242:243], v54 offset:55808
    ds_read_b64_tr_b16 v[244:245], v55 offset:0
    ds_read_b64_tr_b16 v[246:247], v55 offset:512
    ds_read_b64_tr_b16 v[248:249], v55 offset:1024
    ds_read_b64_tr_b16 v[250:251], v55 offset:1536
    ds_read_b64_tr_b16 v[252:253], v55 offset:2048
    ds_read_b64_tr_b16 v[254:255], v55 offset:2560
    s_mov_b32 s36, s12
    s_mov_b32 s37, s13
    s_mov_b32 s38, 0x80000
    s_mov_b32 s39, 0x20000
    s_add_u32 m0, s62, 81920
    s_sub_u32 s64, s80, s58
    s_lshl_b32 s64, s64, 3
    buffer_load_dwordx4 v40, s[36:39], s64 offen offset:0 lds
    buffer_load_dwordx4 v41, s[36:39], s64 offen offset:1024 lds
    buffer_load_dwordx4 v42, s[36:39], s64 offen offset:2048 lds
    buffer_load_dwordx4 v43, s[36:39], s64 offen offset:3072 lds
    s_add_u32 m0, s62, 98304
    s_sub_u32 s64, s81, s58
    s_lshl_b32 s64, s64, 3
    buffer_load_dwordx4 v40, s[36:39], s64 offen offset:0 lds
    buffer_load_dwordx4 v41, s[36:39], s64 offen offset:1024 lds
    buffer_load_dwordx4 v42, s[36:39], s64 offen offset:2048 lds
    buffer_load_dwordx4 v43, s[36:39], s64 offen offset:3072 lds
    s_branch L_pg_12
.p2align 12
L_pg_12:
    s_waitcnt lgkmcnt(0)
    s_barrier
    s_setprio 3
    ds_read_b128 v[4:7], v1 offset:0
    ds_read_b128 v[8:11], v1 offset:1024
    ds_read_b128 v[12:15], v1 offset:2048
    v_mov_b32 v50, 0x3f803f80
    v_mov_b32 v51, 0x3f803f80
    v_mov_b32 v52, 0x3f803f80
    v_mov_b32 v53, 0x3f803f80
    s_waitcnt lgkmcnt(2)
    v_mfma_f32_16x16x32_bf16 v[20:23], v[68:71], v[4:7], 0
    v_mfma_f32_16x16x32_bf16 v[24:27], v[4:7], v[72:75], 0
    ds_read_b128 v[4:7], v1 offset:3072
    s_waitcnt lgkmcnt(2)
    v_mfma_f32_16x16x32_bf16 v[20:23], v[80:83], v[8:11], v[20:23]
    v_mfma_f32_16x16x32_bf16 v[24:27], v[8:11], v[84:87], v[24:27]
    ds_read_b128 v[8:11], v1 offset:4096
    s_waitcnt lgkmcnt(2)
    v_mfma_f32_16x16x32_bf16 v[20:23], v[92:95], v[12:15], v[20:23]
    v_mfma_f32_16x16x32_bf16 v[24:27], v[12:15], v[96:99], v[24:27]
    ds_read_b128 v[12:15], v1 offset:5120
    s_waitcnt lgkmcnt(2)
    v_mfma_f32_16x16x32_bf16 v[20:23], v[104:107], v[4:7], v[20:23]
    v_mfma_f32_16x16x32_bf16 v[24:27], v[4:7], v[108:111], v[24:27]
    ds_read_b128 v[4:7], v1 offset:6144
    s_waitcnt lgkmcnt(2)
    v_mfma_f32_16x16x32_bf16 v[20:23], v[116:119], v[8:11], v[20:23]
    v_mfma_f32_16x16x32_bf16 v[24:27], v[8:11], v[120:123], v[24:27]
    ds_read_b128 v[8:11], v1 offset:7168
    s_waitcnt lgkmcnt(2)
    v_mfma_f32_16x16x32_bf16 v[20:23], v[128:131], v[12:15], v[20:23]
    v_mfma_f32_16x16x32_bf16 v[24:27], v[12:15], v[132:135], v[24:27]
    ds_read_b128 v[12:15], v1 offset:8192
    s_waitcnt lgkmcnt(2)
    v_mfma_f32_16x16x32_bf16 v[20:23], v[140:143], v[4:7], v[20:23]
    v_mfma_f32_16x16x32_bf16 v[24:27], v[4:7], v[144:147], v[24:27]
    ds_read_b128 v[4:7], v1 offset:9216
    s_waitcnt lgkmcnt(2)
    v_mfma_f32_16x16x32_bf16 v[20:23], v[152:155], v[8:11], v[20:23]
    v_mfma_f32_16x16x32_bf16 v[24:27], v[8:11], v[156:159], v[24:27]
    ds_read_b128 v[8:11], v1 offset:10240
    s_waitcnt lgkmcnt(2)
    v_mfma_f32_16x16x32_bf16 v[20:23], v[164:167], v[12:15], v[20:23]
    v_mfma_f32_16x16x32_bf16 v[24:27], v[12:15], v[168:171], v[24:27]
    ds_read_b128 v[12:15], v1 offset:11264
    s_waitcnt lgkmcnt(2)
    v_mfma_f32_16x16x32_bf16 v[20:23], v[176:179], v[4:7], v[20:23]
    v_mfma_f32_16x16x32_bf16 v[24:27], v[4:7], v[180:183], v[24:27]
    ds_read_b128 v[4:7], v1 offset:12288
    s_waitcnt lgkmcnt(2)
    v_mfma_f32_16x16x32_bf16 v[20:23], v[188:191], v[8:11], v[20:23]
    v_mfma_f32_16x16x32_bf16 v[24:27], v[8:11], v[192:195], v[24:27]
    ds_read_b128 v[8:11], v1 offset:13312
    s_waitcnt lgkmcnt(2)
    v_mfma_f32_16x16x32_bf16 v[20:23], v[200:203], v[12:15], v[20:23]
    v_mfma_f32_16x16x32_bf16 v[24:27], v[12:15], v[204:207], v[24:27]
    ds_read_b128 v[12:15], v1 offset:14336
    s_waitcnt lgkmcnt(2)
    v_mfma_f32_16x16x32_bf16 v[20:23], v[212:215], v[4:7], v[20:23]
    v_mfma_f32_16x16x32_bf16 v[24:27], v[4:7], v[216:219], v[24:27]
    ds_read_b128 v[4:7], v1 offset:15360
    s_waitcnt vmcnt(0)
    s_barrier
    s_waitcnt lgkmcnt(2)
    v_mfma_f32_16x16x32_bf16 v[20:23], v[224:227], v[8:11], v[20:23]
    v_mfma_f32_16x16x32_bf16 v[24:27], v[8:11], v[228:231], v[24:27]
    ds_read_b128 v[8:11], v1 offset:16384
    s_waitcnt lgkmcnt(2)
    v_mfma_f32_16x16x32_bf16 v[20:23], v[236:239], v[12:15], v[20:23]
    v_mfma_f32_16x16x32_bf16 v[24:27], v[12:15], v[240:243], v[24:27]
    ds_read_b128 v[12:15], v1 offset:17408
    s_waitcnt lgkmcnt(2)
    v_mfma_f32_16x16x32_bf16 v[20:23], v[248:251], v[4:7], v[20:23]
    v_mfma_f32_16x16x32_bf16 v[24:27], v[4:7], v[252:255], v[24:27]
    ds_read_b128 v[4:7], v1 offset:18432
    s_waitcnt lgkmcnt(2)
    v_mfma_f32_16x16x32_bf16 v[32:35], v[68:71], v[8:11], 0
    v_mfma_f32_16x16x32_bf16 v[28:31], v[64:67], v[8:11], 0
    v_mfma_f32_16x16x32_bf16 v[36:39], v[8:11], v[72:75], 0
    ds_read_b128 v[8:11], v1 offset:19456
    s_waitcnt lgkmcnt(2)
    v_mfma_f32_16x16x32_bf16 v[32:35], v[80:83], v[12:15], v[32:35]
    v_mfma_f32_16x16x32_bf16 v[28:31], v[76:79], v[12:15], v[28:31]
    v_cvt_pk_bf16_f32 v40, v20, v21
    v_cvt_pk_bf16_f32 v41, v22, v23
    v_mfma_f32_16x16x32_bf16 v[36:39], v[12:15], v[84:87], v[36:39]
    ds_read_b128 v[12:15], v1 offset:20480
    s_waitcnt lgkmcnt(2)
    v_mfma_f32_16x16x32_bf16 v[32:35], v[92:95], v[4:7], v[32:35]
    v_cvt_pk_bf16_f32 v58, v24, v25
    v_cvt_pk_bf16_f32 v59, v26, v27
    v_mfma_f32_16x16x32_bf16 v[28:31], v[88:91], v[4:7], v[28:31]
    v_mfma_f32_16x16x32_bf16 v[36:39], v[4:7], v[96:99], v[36:39]
    ds_read_b128 v[4:7], v1 offset:21504
    s_waitcnt lgkmcnt(2)
    v_mfma_f32_16x16x32_bf16 v[32:35], v[104:107], v[8:11], v[32:35]
    v_mfma_f32_16x16x32_bf16 v[28:31], v[100:103], v[8:11], v[28:31]
    v_mfma_f32_16x16x32_bf16 v[36:39], v[8:11], v[108:111], v[36:39]
    ds_read_b128 v[8:11], v1 offset:22528
    s_waitcnt lgkmcnt(2)
    v_mfma_f32_16x16x32_bf16 v[32:35], v[116:119], v[12:15], v[32:35]
    v_mfma_f32_16x16x32_bf16 v[28:31], v[112:115], v[12:15], v[28:31]
    v_mfma_f32_16x16x32_bf16 v[36:39], v[12:15], v[120:123], v[36:39]
    ds_read_b128 v[12:15], v1 offset:23552
    s_waitcnt lgkmcnt(2)
    v_mfma_f32_16x16x32_bf16 v[32:35], v[128:131], v[4:7], v[32:35]
    v_mfma_f32_16x16x32_bf16 v[28:31], v[124:127], v[4:7], v[28:31]
    v_mfma_f32_16x16x32_bf16 v[36:39], v[4:7], v[132:135], v[36:39]
    ds_read_b128 v[4:7], v1 offset:24576
    s_waitcnt lgkmcnt(2)
    v_mfma_f32_16x16x32_bf16 v[32:35], v[140:143], v[8:11], v[32:35]
    v_mfma_f32_16x16x32_bf16 v[28:31], v[136:139], v[8:11], v[28:31]
    v_mfma_f32_16x16x32_bf16 v[36:39], v[8:11], v[144:147], v[36:39]
    ds_read_b128 v[8:11], v1 offset:25600
    s_waitcnt lgkmcnt(2)
    v_mfma_f32_16x16x32_bf16 v[32:35], v[152:155], v[12:15], v[32:35]
    v_mfma_f32_16x16x32_bf16 v[28:31], v[148:151], v[12:15], v[28:31]
    v_mfma_f32_16x16x32_bf16 v[36:39], v[12:15], v[156:159], v[36:39]
    ds_read_b128 v[12:15], v1 offset:26624
    s_waitcnt lgkmcnt(2)
    v_mfma_f32_16x16x32_bf16 v[32:35], v[164:167], v[4:7], v[32:35]
    v_mfma_f32_16x16x32_bf16 v[28:31], v[160:163], v[4:7], v[28:31]
    v_mfma_f32_16x16x32_bf16 v[36:39], v[4:7], v[168:171], v[36:39]
    ds_read_b128 v[4:7], v1 offset:27648
    s_waitcnt lgkmcnt(2)
    v_mfma_f32_16x16x32_bf16 v[32:35], v[176:179], v[8:11], v[32:35]
    v_mfma_f32_16x16x32_bf16 v[28:31], v[172:175], v[8:11], v[28:31]
    v_mfma_f32_16x16x32_bf16 v[36:39], v[8:11], v[180:183], v[36:39]
    ds_read_b128 v[8:11], v1 offset:28672
    s_waitcnt lgkmcnt(2)
    v_mfma_f32_16x16x32_bf16 v[32:35], v[188:191], v[12:15], v[32:35]
    v_mfma_f32_16x16x32_bf16 v[28:31], v[184:187], v[12:15], v[28:31]
    v_mfma_f32_16x16x32_bf16 v[36:39], v[12:15], v[192:195], v[36:39]
    ds_read_b128 v[12:15], v1 offset:29696
    s_waitcnt lgkmcnt(2)
    v_mfma_f32_16x16x32_bf16 v[32:35], v[200:203], v[4:7], v[32:35]
    v_mfma_f32_16x16x32_bf16 v[28:31], v[196:199], v[4:7], v[28:31]
    v_mfma_f32_16x16x32_bf16 v[36:39], v[4:7], v[204:207], v[36:39]
    ds_read_b128 v[4:7], v1 offset:30720
    s_waitcnt lgkmcnt(2)
    v_mfma_f32_16x16x32_bf16 v[32:35], v[212:215], v[8:11], v[32:35]
    v_mfma_f32_16x16x32_bf16 v[28:31], v[208:211], v[8:11], v[28:31]
    v_mfma_f32_16x16x32_bf16 v[36:39], v[8:11], v[216:219], v[36:39]
    ds_read_b128 v[8:11], v1 offset:31744
    s_barrier
    s_waitcnt lgkmcnt(2)
    v_mfma_f32_16x16x32_bf16 v[32:35], v[224:227], v[12:15], v[32:35]
    v_mfma_f32_16x16x32_bf16 v[28:31], v[220:223], v[12:15], v[28:31]
    v_mfma_f32_16x16x32_bf16 v[36:39], v[12:15], v[228:231], v[36:39]
    ds_read_b128 v[12:15], v1 offset:32768
    s_waitcnt lgkmcnt(2)
    v_mfma_f32_16x16x32_bf16 v[32:35], v[236:239], v[4:7], v[32:35]
    v_mfma_f32_16x16x32_bf16 v[28:31], v[232:235], v[4:7], v[28:31]
    v_mfma_f32_16x16x32_bf16 v[36:39], v[4:7], v[240:243], v[36:39]
    ds_read_b128 v[4:7], v1 offset:33792
    s_waitcnt lgkmcnt(2)
    v_mfma_f32_16x16x32_bf16 v[32:35], v[248:251], v[8:11], v[32:35]
    v_mfma_f32_16x16x32_bf16 v[28:31], v[244:247], v[8:11], v[28:31]
    v_mfma_f32_16x16x32_bf16 v[36:39], v[8:11], v[252:255], v[36:39]
    ds_read_b128 v[8:11], v1 offset:34816
    s_waitcnt lgkmcnt(2)
    v_mfma_f32_16x16x32_bf16 v[20:23], v[68:71], v[12:15], 0
    v_mfma_f32_16x16x32_bf16 v[16:19], v[64:67], v[12:15], 0
    v_mfma_f32_16x16x32_bf16 v[24:27], v[12:15], v[72:75], 0
    ds_read_b128 v[12:15], v1 offset:35840
    s_waitcnt lgkmcnt(2)
    v_mfma_f32_16x16x32_bf16 v[20:23], v[80:83], v[4:7], v[20:23]
    v_mfma_f32_16x16x32_bf16 v[16:19], v[76:79], v[4:7], v[16:19]
    v_cvt_pk_bf16_f32 v42, v32, v33
    v_cvt_pk_bf16_f32 v43, v34, v35
    v_mfma_f32_16x16x32_bf16 v[24:27], v[4:7], v[84:87], v[24:27]
    ds_read_b128 v[4:7], v1 offset:36864
    s_waitcnt lgkmcnt(2)
    v_mfma_f32_16x16x32_bf16 v[20:23], v[92:95], v[8:11], v[20:23]
    v_cvt_pk_bf16_f32 v28, v28, v29
    v_cvt_pk_bf16_f32 v29, v30, v31
    v_mfma_f32_16x16x32_bf16 v[16:19], v[88:91], v[8:11], v[16:19]
    v_cvt_pk_bf16_f32 v60, v36, v37
    v_cvt_pk_bf16_f32 v61, v38, v39
    v_mfma_f32_16x16x32_bf16 v[24:27], v[8:11], v[96:99], v[24:27]
    ds_read_b128 v[8:11], v1 offset:37888
    s_waitcnt lgkmcnt(2)
    v_mfma_f32_16x16x32_bf16 v[20:23], v[104:107], v[12:15], v[20:23]
    v_mfma_f32_16x16x16_bf16 v[32:35], v[42:43], v[28:29], 0
    v_mfma_f32_16x16x32_bf16 v[16:19], v[100:103], v[12:15], v[16:19]
    v_mfma_f32_16x16x16_bf16 v[36:39], v[40:41], v[28:29], 0
    v_mfma_f32_16x16x32_bf16 v[24:27], v[12:15], v[108:111], v[24:27]
    ds_read_b128 v[12:15], v1 offset:38912
    s_waitcnt lgkmcnt(2)
    v_mfma_f32_16x16x32_bf16 v[20:23], v[116:119], v[4:7], v[20:23]
    v_mfma_f32_16x16x32_bf16 v[16:19], v[112:115], v[4:7], v[16:19]
    v_mfma_f32_16x16x32_bf16 v[24:27], v[4:7], v[120:123], v[24:27]
    ds_read_b128 v[4:7], v1 offset:39936
    s_waitcnt lgkmcnt(2)
    v_mfma_f32_16x16x32_bf16 v[20:23], v[128:131], v[8:11], v[20:23]
    v_mfma_f32_16x16x32_bf16 v[16:19], v[124:127], v[8:11], v[16:19]
    v_cndmask_b32 v32, v32, v33, s[72:73]
    v_cndmask_b32 v34, v34, v35, s[72:73]
    v_mfma_f32_16x16x32_bf16 v[24:27], v[8:11], v[132:135], v[24:27]
    ds_read_b128 v[8:11], v1 offset:40960
    s_waitcnt lgkmcnt(2)
    v_mfma_f32_16x16x32_bf16 v[20:23], v[140:143], v[12:15], v[20:23]
    v_cndmask_b32 v36, v36, v37, s[72:73]
    v_cndmask_b32 v38, v38, v39, s[72:73]
    v_mfma_f32_16x16x32_bf16 v[16:19], v[136:139], v[12:15], v[16:19]
    v_add_f32 v36, s84, v36
    v_add_f32 v38, s84, v38
    v_mfma_f32_16x16x32_bf16 v[24:27], v[12:15], v[144:147], v[24:27]
    ds_read_b128 v[12:15], v1 offset:41984
    s_waitcnt lgkmcnt(2)
    v_mfma_f32_16x16x32_bf16 v[20:23], v[152:155], v[4:7], v[20:23]
    v_cndmask_b32 v28, v36, v32, s[74:75]
    v_cndmask_b32 v29, v38, v34, s[76:77]
    v_mfma_f32_16x16x32_bf16 v[16:19], v[148:151], v[4:7], v[16:19]
    v_max_f32 v30, v28, v29
    v_max_f32 v31, v28, v29
    v_mfma_f32_16x16x32_bf16 v[24:27], v[4:7], v[156:159], v[24:27]
    ds_read_b128 v[4:7], v1 offset:43008
    s_waitcnt lgkmcnt(2)
    v_mfma_f32_16x16x32_bf16 v[20:23], v[164:167], v[8:11], v[20:23]
    v_mul_f32 v28, s94, v28
    v_mul_f32 v29, s94, v29
    v_mfma_f32_16x16x32_bf16 v[16:19], v[160:163], v[8:11], v[16:19]
    v_permlane32_swap_b32 v30, v31
    v_mfma_f32_16x16x32_bf16 v[24:27], v[8:11], v[168:171], v[24:27]
    ds_read_b128 v[8:11], v1 offset:44032
    s_waitcnt lgkmcnt(2)
    v_mfma_f32_16x16x32_bf16 v[20:23], v[176:179], v[12:15], v[20:23]
    v_max_f32 v32, v30, v31
    v_max_f32 v33, v30, v31
    v_mfma_f32_16x16x32_bf16 v[16:19], v[172:175], v[12:15], v[16:19]
    v_mfma_f32_16x16x32_bf16 v[24:27], v[12:15], v[180:183], v[24:27]
    ds_read_b128 v[12:15], v1 offset:45056
    s_waitcnt lgkmcnt(2)
    v_mfma_f32_16x16x32_bf16 v[20:23], v[188:191], v[4:7], v[20:23]
    v_permlane16_swap_b32 v32, v33
    v_mfma_f32_16x16x32_bf16 v[16:19], v[184:187], v[4:7], v[16:19]
    v_max_f32 v30, v32, v33
    v_fma_f32 v28, -v30, s94, v28
    v_mfma_f32_16x16x32_bf16 v[24:27], v[4:7], v[192:195], v[24:27]
    ds_read_b128 v[4:7], v1 offset:46080
    s_waitcnt lgkmcnt(2)
    v_mfma_f32_16x16x32_bf16 v[20:23], v[200:203], v[8:11], v[20:23]
    v_fma_f32 v29, -v30, s94, v29
    v_exp_f32 v28, v28
    v_mfma_f32_16x16x32_bf16 v[16:19], v[196:199], v[8:11], v[16:19]
    v_exp_f32 v29, v29
    v_mfma_f32_16x16x32_bf16 v[24:27], v[8:11], v[204:207], v[24:27]
    ds_read_b128 v[8:11], v1 offset:47104
    s_waitcnt lgkmcnt(2)
    v_mfma_f32_16x16x32_bf16 v[20:23], v[212:215], v[12:15], v[20:23]
    v_cvt_pk_bf16_f32 v30, v28, v29
    v_perm_b32 v38, v30, v30, v46
    v_mfma_f32_16x16x32_bf16 v[16:19], v[208:211], v[12:15], v[16:19]
    v_perm_b32 v39, v30, v30, v47
    v_perm_b32 v36, v30, v30, v48
    v_mfma_f32_16x16x32_bf16 v[24:27], v[12:15], v[216:219], v[24:27]
    ds_read_b128 v[12:15], v1 offset:48128
    s_barrier
    s_waitcnt lgkmcnt(2)
    v_mfma_f32_16x16x32_bf16 v[20:23], v[224:227], v[4:7], v[20:23]
    v_perm_b32 v37, v30, v30, v49
    v_mfma_f32_16x16x32_bf16 v[16:19], v[220:223], v[4:7], v[16:19]
    s_nop 0
    v_mfma_f32_16x16x32_bf16 v[28:31], v[50:53], v[36:39], 0
    v_mfma_f32_16x16x32_bf16 v[24:27], v[4:7], v[228:231], v[24:27]
    ds_read_b128 v[4:7], v1 offset:49152
    s_waitcnt lgkmcnt(2)
    v_mfma_f32_16x16x32_bf16 v[20:23], v[236:239], v[8:11], v[20:23]
    v_mfma_f32_16x16x32_bf16 v[32:35], v[58:61], v[36:39], 0
    v_mfma_f32_16x16x32_bf16 v[16:19], v[232:235], v[8:11], v[16:19]
    v_mfma_f32_16x16x32_bf16 v[24:27], v[8:11], v[240:243], v[24:27]
    ds_read_b128 v[8:11], v1 offset:50176
    s_waitcnt lgkmcnt(2)
    v_mfma_f32_16x16x32_bf16 v[20:23], v[248:251], v[12:15], v[20:23]
    v_mfma_f32_16x16x32_bf16 v[16:19], v[244:247], v[12:15], v[16:19]
    v_mfma_f32_16x16x32_bf16 v[24:27], v[12:15], v[252:255], v[24:27]
    ds_read_b128 v[12:15], v1 offset:51200
    v_rcp_f32 v28, v28
    s_nop 0
    v_mul_f32 v32, v32, v28
    v_mul_f32 v33, v33, v28
    v_mul_f32 v34, v34, v28
    v_mul_f32 v35, v35, v28
    v_cvt_pk_bf16_f32 v54, v32, v33
    v_cvt_pk_bf16_f32 v55, v34, v35
    s_waitcnt lgkmcnt(2)
    v_mfma_f32_16x16x32_bf16 v[32:35], v[68:71], v[4:7], 0
    v_mfma_f32_16x16x32_bf16 v[28:31], v[64:67], v[4:7], 0
    v_mfma_f32_16x16x32_bf16 v[36:39], v[4:7], v[72:75], 0
    ds_read_b128 v[4:7], v1 offset:52224
    s_waitcnt lgkmcnt(2)
    v_mfma_f32_16x16x32_bf16 v[32:35], v[80:83], v[8:11], v[32:35]
    v_mfma_f32_16x16x32_bf16 v[28:31], v[76:79], v[8:11], v[28:31]
    v_cvt_pk_bf16_f32 v40, v20, v21
    v_cvt_pk_bf16_f32 v41, v22, v23
    v_mfma_f32_16x16x32_bf16 v[36:39], v[8:11], v[84:87], v[36:39]
    ds_read_b128 v[8:11], v1 offset:53248
    s_waitcnt lgkmcnt(2)
    v_mfma_f32_16x16x32_bf16 v[32:35], v[92:95], v[12:15], v[32:35]
    v_cvt_pk_bf16_f32 v16, v16, v17
    v_cvt_pk_bf16_f32 v17, v18, v19
    v_mfma_f32_16x16x32_bf16 v[28:31], v[88:91], v[12:15], v[28:31]
    v_cvt_pk_bf16_f32 v58, v24, v25
    v_cvt_pk_bf16_f32 v59, v26, v27
    v_mfma_f32_16x16x32_bf16 v[36:39], v[12:15], v[96:99], v[36:39]
    ds_read_b128 v[12:15], v1 offset:54272
    s_waitcnt lgkmcnt(2)
    v_mfma_f32_16x16x32_bf16 v[32:35], v[104:107], v[4:7], v[32:35]
    v_mfma_f32_16x16x16_bf16 v[20:23], v[40:41], v[16:17], 0
    v_mfma_f32_16x16x32_bf16 v[28:31], v[100:103], v[4:7], v[28:31]
    v_mfma_f32_16x16x16_bf16 v[24:27], v[42:43], v[16:17], 0
    v_mfma_f32_16x16x32_bf16 v[36:39], v[4:7], v[108:111], v[36:39]
    ds_read_b128 v[4:7], v1 offset:55296
    s_waitcnt lgkmcnt(2)
    v_mfma_f32_16x16x32_bf16 v[32:35], v[116:119], v[8:11], v[32:35]
    v_mfma_f32_16x16x32_bf16 v[28:31], v[112:115], v[8:11], v[28:31]
    v_mfma_f32_16x16x32_bf16 v[36:39], v[8:11], v[120:123], v[36:39]
    ds_read_b128 v[8:11], v1 offset:56320
    s_waitcnt lgkmcnt(2)
    v_mfma_f32_16x16x32_bf16 v[32:35], v[128:131], v[12:15], v[32:35]
    v_mfma_f32_16x16x32_bf16 v[28:31], v[124:127], v[12:15], v[28:31]
    v_cndmask_b32 v20, v20, v21, s[72:73]
    v_cndmask_b32 v22, v22, v23, s[72:73]
    v_mfma_f32_16x16x32_bf16 v[36:39], v[12:15], v[132:135], v[36:39]
    ds_read_b128 v[12:15], v1 offset:57344
    s_waitcnt lgkmcnt(2)
    v_mfma_f32_16x16x32_bf16 v[32:35], v[140:143], v[4:7], v[32:35]
    v_cndmask_b32 v24, v24, v25, s[72:73]
    v_cndmask_b32 v26, v26, v27, s[72:73]
    v_mfma_f32_16x16x32_bf16 v[28:31], v[136:139], v[4:7], v[28:31]
    v_cndmask_b32 v16, v24, v20, s[74:75]
    v_cndmask_b32 v17, v26, v22, s[76:77]
    v_mfma_f32_16x16x32_bf16 v[36:39], v[4:7], v[144:147], v[36:39]
    ds_read_b128 v[4:7], v1 offset:58368
    s_waitcnt lgkmcnt(2)
    v_mfma_f32_16x16x32_bf16 v[32:35], v[152:155], v[8:11], v[32:35]
    v_max_f32 v18, v16, v17
    v_max_f32 v19, v16, v17
    v_mfma_f32_16x16x32_bf16 v[28:31], v[148:151], v[8:11], v[28:31]
    v_mul_f32 v16, s94, v16
    v_mul_f32 v17, s94, v17
    v_mfma_f32_16x16x32_bf16 v[36:39], v[8:11], v[156:159], v[36:39]
    ds_read_b128 v[8:11], v1 offset:59392
    s_waitcnt lgkmcnt(2)
    v_mfma_f32_16x16x32_bf16 v[32:35], v[164:167], v[12:15], v[32:35]
    v_permlane32_swap_b32 v18, v19
    v_mfma_f32_16x16x32_bf16 v[28:31], v[160:163], v[12:15], v[28:31]
    v_max_f32 v20, v18, v19
    v_max_f32 v21, v18, v19
    v_mfma_f32_16x16x32_bf16 v[36:39], v[12:15], v[168:171], v[36:39]
    ds_read_b128 v[12:15], v1 offset:60416
    s_waitcnt lgkmcnt(2)
    v_mfma_f32_16x16x32_bf16 v[32:35], v[176:179], v[4:7], v[32:35]
    v_mfma_f32_16x16x32_bf16 v[28:31], v[172:175], v[4:7], v[28:31]
    v_permlane16_swap_b32 v20, v21
    v_mfma_f32_16x16x32_bf16 v[36:39], v[4:7], v[180:183], v[36:39]
    ds_read_b128 v[4:7], v1 offset:61440
    s_waitcnt lgkmcnt(2)
    v_mfma_f32_16x16x32_bf16 v[32:35], v[188:191], v[8:11], v[32:35]
    v_max_f32 v18, v20, v21
    v_fma_f32 v16, -v18, s94, v16
    v_mfma_f32_16x16x32_bf16 v[28:31], v[184:187], v[8:11], v[28:31]
    v_fma_f32 v17, -v18, s94, v17
    v_exp_f32 v16, v16
    v_mfma_f32_16x16x32_bf16 v[36:39], v[8:11], v[192:195], v[36:39]
    ds_read_b128 v[8:11], v1 offset:62464
    s_waitcnt lgkmcnt(2)
    v_mfma_f32_16x16x32_bf16 v[32:35], v[200:203], v[12:15], v[32:35]
    v_exp_f32 v17, v17
    v_mfma_f32_16x16x32_bf16 v[28:31], v[196:199], v[12:15], v[28:31]
    v_cvt_pk_bf16_f32 v18, v16, v17
    v_perm_b32 v24, v18, v18, v46
    v_mfma_f32_16x16x32_bf16 v[36:39], v[12:15], v[204:207], v[36:39]
    ds_read_b128 v[12:15], v1 offset:63488
    s_waitcnt lgkmcnt(2)
    v_mfma_f32_16x16x32_bf16 v[32:35], v[212:215], v[4:7], v[32:35]
    v_perm_b32 v25, v18, v18, v47
    v_perm_b32 v26, v18, v18, v48
    v_mfma_f32_16x16x32_bf16 v[28:31], v[208:211], v[4:7], v[28:31]
    v_perm_b32 v27, v18, v18, v49
    v_mfma_f32_16x16x32_bf16 v[36:39], v[4:7], v[216:219], v[36:39]
    ds_read_b128 v[4:7], v1 offset:64512
    s_barrier
    s_waitcnt lgkmcnt(2)
    v_mfma_f32_16x16x32_bf16 v[32:35], v[224:227], v[8:11], v[32:35]
    v_mfma_f32_16x16x32_bf16 v[16:19], v[50:53], v[24:27], 0
    v_mfma_f32_16x16x32_bf16 v[28:31], v[220:223], v[8:11], v[28:31]
    v_mfma_f32_16x16x32_bf16 v[20:23], v[58:61], v[24:27], 0
    v_mfma_f32_16x16x32_bf16 v[36:39], v[8:11], v[228:231], v[36:39]
    v_add_u32 v1, 0x10000, v1
    ds_read_b128 v[8:11], v1 offset:0
    s_waitcnt lgkmcnt(2)
    v_mfma_f32_16x16x32_bf16 v[32:35], v[236:239], v[12:15], v[32:35]
    v_mfma_f32_16x16x32_bf16 v[28:31], v[232:235], v[12:15], v[28:31]
    v_mfma_f32_16x16x32_bf16 v[36:39], v[12:15], v[240:243], v[36:39]
    ds_read_b128 v[12:15], v1 offset:1024
    s_waitcnt lgkmcnt(2)
    v_mfma_f32_16x16x32_bf16 v[32:35], v[248:251], v[4:7], v[32:35]
    v_mfma_f32_16x16x32_bf16 v[28:31], v[244:247], v[4:7], v[28:31]
    v_rcp_f32 v16, v16
    v_mfma_f32_16x16x32_bf16 v[36:39], v[4:7], v[252:255], v[36:39]
    ds_read_b128 v[4:7], v1 offset:2048
    v_mul_f32 v20, v20, v16
    v_mul_f32 v21, v21, v16
    v_mul_f32 v22, v22, v16
    v_mul_f32 v23, v23, v16
    v_cvt_pk_bf16_f32 v56, v20, v21
    v_cvt_pk_bf16_f32 v57, v22, v23
    s_nop 0
    v_permlane16_swap_b32 v54, v56
    v_permlane16_swap_b32 v55, v57
    buffer_store_dwordx4 v[54:57], v3, s[40:43], s58 offen offset:0 sc1
    s_waitcnt lgkmcnt(2)
    v_mfma_f32_16x16x32_bf16 v[20:23], v[68:71], v[8:11], 0
    v_mfma_f32_16x16x32_bf16 v[16:19], v[64:67], v[8:11], 0
    v_mfma_f32_16x16x32_bf16 v[24:27], v[8:11], v[72:75], 0
    ds_read_b128 v[8:11], v1 offset:3072
    s_waitcnt lgkmcnt(2)
    v_mfma_f32_16x16x32_bf16 v[20:23], v[80:83], v[12:15], v[20:23]
    v_mfma_f32_16x16x32_bf16 v[16:19], v[76:79], v[12:15], v[16:19]
    v_cvt_pk_bf16_f32 v42, v32, v33
    v_cvt_pk_bf16_f32 v43, v34, v35
    v_mfma_f32_16x16x32_bf16 v[24:27], v[12:15], v[84:87], v[24:27]
    ds_read_b128 v[12:15], v1 offset:4096
    s_waitcnt lgkmcnt(2)
    v_mfma_f32_16x16x32_bf16 v[20:23], v[92:95], v[4:7], v[20:23]
    v_cvt_pk_bf16_f32 v28, v28, v29
    v_cvt_pk_bf16_f32 v29, v30, v31
    v_mfma_f32_16x16x32_bf16 v[16:19], v[88:91], v[4:7], v[16:19]
    v_cvt_pk_bf16_f32 v60, v36, v37
    v_cvt_pk_bf16_f32 v61, v38, v39
    v_mfma_f32_16x16x32_bf16 v[24:27], v[4:7], v[96:99], v[24:27]
    ds_read_b128 v[4:7], v1 offset:5120
    s_waitcnt lgkmcnt(2)
    v_mfma_f32_16x16x32_bf16 v[20:23], v[104:107], v[8:11], v[20:23]
    v_mfma_f32_16x16x16_bf16 v[32:35], v[42:43], v[28:29], 0
    v_mfma_f32_16x16x32_bf16 v[16:19], v[100:103], v[8:11], v[16:19]
    v_mfma_f32_16x16x16_bf16 v[36:39], v[40:41], v[28:29], 0
    v_mfma_f32_16x16x32_bf16 v[24:27], v[8:11], v[108:111], v[24:27]
    ds_read_b128 v[8:11], v1 offset:6144
    s_barrier
    s_waitcnt lgkmcnt(2)
    v_mfma_f32_16x16x32_bf16 v[20:23], v[116:119], v[12:15], v[20:23]
    v_mfma_f32_16x16x32_bf16 v[16:19], v[112:115], v[12:15], v[16:19]
    v_mfma_f32_16x16x32_bf16 v[24:27], v[12:15], v[120:123], v[24:27]
    ds_read_b128 v[12:15], v1 offset:7168
    s_waitcnt lgkmcnt(2)
    v_mfma_f32_16x16x32_bf16 v[20:23], v[128:131], v[4:7], v[20:23]
    v_mfma_f32_16x16x32_bf16 v[16:19], v[124:127], v[4:7], v[16:19]
    v_cndmask_b32 v32, v32, v33, s[72:73]
    v_cndmask_b32 v34, v34, v35, s[72:73]
    v_mfma_f32_16x16x32_bf16 v[24:27], v[4:7], v[132:135], v[24:27]
    ds_read_b128 v[4:7], v1 offset:8192
    s_waitcnt lgkmcnt(2)
    v_mfma_f32_16x16x32_bf16 v[20:23], v[140:143], v[8:11], v[20:23]
    v_cndmask_b32 v36, v36, v37, s[72:73]
    v_cndmask_b32 v38, v38, v39, s[72:73]
    v_mfma_f32_16x16x32_bf16 v[16:19], v[136:139], v[8:11], v[16:19]
    v_cndmask_b32 v28, v36, v32, s[74:75]
    v_cndmask_b32 v29, v38, v34, s[76:77]
    v_mfma_f32_16x16x32_bf16 v[24:27], v[8:11], v[144:147], v[24:27]
    ds_read_b128 v[8:11], v1 offset:9216
    s_waitcnt lgkmcnt(2)
    v_mfma_f32_16x16x32_bf16 v[20:23], v[152:155], v[12:15], v[20:23]
    v_max_f32 v30, v28, v29
    v_max_f32 v31, v28, v29
    v_mfma_f32_16x16x32_bf16 v[16:19], v[148:151], v[12:15], v[16:19]
    v_mul_f32 v28, s94, v28
    v_mul_f32 v29, s94, v29
    v_mfma_f32_16x16x32_bf16 v[24:27], v[12:15], v[156:159], v[24:27]
    ds_read_b128 v[12:15], v1 offset:10240
    s_waitcnt lgkmcnt(2)
    v_mfma_f32_16x16x32_bf16 v[20:23], v[164:167], v[4:7], v[20:23]
    v_permlane32_swap_b32 v30, v31
    v_mfma_f32_16x16x32_bf16 v[16:19], v[160:163], v[4:7], v[16:19]
    v_max_f32 v32, v30, v31
    v_max_f32 v33, v30, v31
    v_mfma_f32_16x16x32_bf16 v[24:27], v[4:7], v[168:171], v[24:27]
    ds_read_b128 v[4:7], v1 offset:11264
    s_waitcnt lgkmcnt(2)
    v_mfma_f32_16x16x32_bf16 v[20:23], v[176:179], v[8:11], v[20:23]
    v_mfma_f32_16x16x32_bf16 v[16:19], v[172:175], v[8:11], v[16:19]
    v_permlane16_swap_b32 v32, v33
    v_mfma_f32_16x16x32_bf16 v[24:27], v[8:11], v[180:183], v[24:27]
    ds_read_b128 v[8:11], v1 offset:12288
    s_waitcnt lgkmcnt(2)
    v_mfma_f32_16x16x32_bf16 v[20:23], v[188:191], v[12:15], v[20:23]
    v_max_f32 v30, v32, v33
    v_fma_f32 v28, -v30, s94, v28
    v_mfma_f32_16x16x32_bf16 v[16:19], v[184:187], v[12:15], v[16:19]
    v_fma_f32 v29, -v30, s94, v29
    v_exp_f32 v28, v28
    v_mfma_f32_16x16x32_bf16 v[24:27], v[12:15], v[192:195], v[24:27]
    ds_read_b128 v[12:15], v1 offset:13312
    s_waitcnt lgkmcnt(2)
    v_mfma_f32_16x16x32_bf16 v[20:23], v[200:203], v[4:7], v[20:23]
    v_exp_f32 v29, v29
    v_mfma_f32_16x16x32_bf16 v[16:19], v[196:199], v[4:7], v[16:19]
    v_cvt_pk_bf16_f32 v30, v28, v29
    v_perm_b32 v38, v30, v30, v46
    v_mfma_f32_16x16x32_bf16 v[24:27], v[4:7], v[204:207], v[24:27]
    ds_read_b128 v[4:7], v1 offset:14336
    s_waitcnt lgkmcnt(2)
    v_mfma_f32_16x16x32_bf16 v[20:23], v[212:215], v[8:11], v[20:23]
    v_perm_b32 v39, v30, v30, v47
    v_perm_b32 v36, v30, v30, v48
    v_mfma_f32_16x16x32_bf16 v[16:19], v[208:211], v[8:11], v[16:19]
    v_perm_b32 v37, v30, v30, v49
    v_mfma_f32_16x16x32_bf16 v[24:27], v[8:11], v[216:219], v[24:27]
    ds_read_b128 v[8:11], v1 offset:15360
    s_waitcnt lgkmcnt(2)
    v_mfma_f32_16x16x32_bf16 v[20:23], v[224:227], v[12:15], v[20:23]
    v_mfma_f32_16x16x32_bf16 v[28:31], v[50:53], v[36:39], 0
    v_mfma_f32_16x16x32_bf16 v[16:19], v[220:223], v[12:15], v[16:19]
    v_mfma_f32_16x16x32_bf16 v[32:35], v[58:61], v[36:39], 0
    v_mfma_f32_16x16x32_bf16 v[24:27], v[12:15], v[228:231], v[24:27]
    s_waitcnt lgkmcnt(1)
    v_mfma_f32_16x16x32_bf16 v[20:23], v[236:239], v[4:7], v[20:23]
    v_mfma_f32_16x16x32_bf16 v[16:19], v[232:235], v[4:7], v[16:19]
    v_mfma_f32_16x16x32_bf16 v[24:27], v[4:7], v[240:243], v[24:27]
    s_waitcnt lgkmcnt(0)
    v_mfma_f32_16x16x32_bf16 v[20:23], v[248:251], v[8:11], v[20:23]
    v_mfma_f32_16x16x32_bf16 v[16:19], v[244:247], v[8:11], v[16:19]
    v_rcp_f32 v28, v28
    v_mfma_f32_16x16x32_bf16 v[24:27], v[8:11], v[252:255], v[24:27]
    v_mul_f32 v32, v32, v28
    v_mul_f32 v33, v33, v28
    v_mul_f32 v34, v34, v28
    v_mul_f32 v35, v35, v28
    v_cvt_pk_bf16_f32 v54, v32, v33
    v_cvt_pk_bf16_f32 v55, v34, v35
    v_cvt_pk_bf16_f32 v40, v20, v21
    v_cvt_pk_bf16_f32 v41, v22, v23
    v_cvt_pk_bf16_f32 v16, v16, v17
    v_cvt_pk_bf16_f32 v17, v18, v19
    v_cvt_pk_bf16_f32 v58, v24, v25
    v_cvt_pk_bf16_f32 v59, v26, v27
    v_mfma_f32_16x16x16_bf16 v[20:23], v[40:41], v[16:17], 0
    v_mfma_f32_16x16x16_bf16 v[24:27], v[42:43], v[16:17], 0
    s_nop 6
    v_cndmask_b32 v20, v20, v21, s[72:73]
    v_cndmask_b32 v22, v22, v23, s[72:73]
    v_cndmask_b32 v24, v24, v25, s[72:73]
    v_cndmask_b32 v26, v26, v27, s[72:73]
    v_cndmask_b32 v16, v24, v20, s[74:75]
    v_cndmask_b32 v17, v26, v22, s[76:77]
    v_max_f32 v18, v16, v17
    v_max_f32 v19, v16, v17
    v_mul_f32 v16, s94, v16
    v_mul_f32 v17, s94, v17
    v_permlane32_swap_b32 v18, v19
    v_max_f32 v20, v18, v19
    v_max_f32 v21, v18, v19
    s_nop 1
    v_permlane16_swap_b32 v20, v21
    v_max_f32 v18, v20, v21
    v_fma_f32 v16, -v18, s94, v16
    v_fma_f32 v17, -v18, s94, v17
    v_exp_f32 v16, v16
    v_exp_f32 v17, v17
    s_nop 0
    v_cvt_pk_bf16_f32 v18, v16, v17
    v_perm_b32 v24, v18, v18, v46
    v_perm_b32 v25, v18, v18, v47
    v_perm_b32 v26, v18, v18, v48
    v_perm_b32 v27, v18, v18, v49
    s_nop 1
    v_mfma_f32_16x16x32_bf16 v[16:19], v[50:53], v[24:27], 0
    v_mfma_f32_16x16x32_bf16 v[20:23], v[58:61], v[24:27], 0
    s_nop 6
    v_rcp_f32 v16, v16
    s_nop 0
    v_mul_f32 v20, v20, v16
    v_mul_f32 v21, v21, v16
    v_mul_f32 v22, v22, v16
    v_mul_f32 v23, v23, v16
    v_cvt_pk_bf16_f32 v56, v20, v21
    v_cvt_pk_bf16_f32 v57, v22, v23
    s_nop 0
    v_permlane16_swap_b32 v54, v56
    v_permlane16_swap_b32 v55, v57
    buffer_store_dwordx4 v[54:57], v3, s[40:43], s58 offen offset:512 sc1
    v_lshlrev_b32 v1, 4, v0
    s_lshl_b32 s64, s53, 2
    v_mov_b32 v10, s64
    s_add_u32 s92, s56, 2
    v_mov_b32 v11, s92
    v_and_b32 v13, 7, v0
    v_lshlrev_b32 v13, 2, v13
    s_waitcnt vmcnt(0) lgkmcnt(0)
    s_barrier
    s_setprio 2
    s_cmp_lg_u32 s52, 0
    s_cbranch_scc1 L_pub_13n
    s_cmp_eq_u32 s57, 0
    s_cbranch_scc1 L_st_14s
    buffer_store_dword v11, v10, s[40:43], s93 offen
L_st_14e:
L_pub_13n:
    s_and_b32 s64, s52, 1
    s_lshl_b32 s64, s64, 10
    s_add_u32 s64, s64, 155648
    v_add_u32 v6, s64, v1
    ds_read_b128 v[6:9], v6
    ds_read_b64_tr_b16 v[192:193], v44 offset:0
    ds_read_b64_tr_b16 v[194:195], v44 offset:512
    ds_read_b64_tr_b16 v[196:197], v44 offset:4096
    ds_read_b64_tr_b16 v[198:199], v44 offset:4608
    ds_read_b64_tr_b16 v[200:201], v44 offset:8192
    ds_read_b64_tr_b16 v[202:203], v44 offset:8704
    ds_read_b64_tr_b16 v[204:205], v44 offset:12288
    ds_read_b64_tr_b16 v[206:207], v44 offset:12800
    ds_read_b64_tr_b16 v[208:209], v44 offset:16384
    ds_read_b64_tr_b16 v[210:211], v44 offset:16896
    ds_read_b64_tr_b16 v[212:213], v44 offset:20480
    ds_read_b64_tr_b16 v[214:215], v44 offset:20992
    ds_read_b64_tr_b16 v[216:217], v44 offset:24576
    ds_read_b64_tr_b16 v[218:219], v44 offset:25088
    s_cmp_lg_u32 s52, 0
    s_cbranch_scc1 L_pol_15
    buffer_load_dword v12, v13, s[40:43], s93 offen sc1
L_pol_15:
    ds_read_b64_tr_b16 v[220:221], v44 offset:28672
    ds_read_b64_tr_b16 v[222:223], v44 offset:29184
    ds_read_b64_tr_b16 v[224:225], v44 offset:32768
    ds_read_b64_tr_b16 v[226:227], v44 offset:33280
    ds_read_b64_tr_b16 v[228:229], v44 offset:36864
    ds_read_b64_tr_b16 v[230:231], v44 offset:37376
    ds_read_b64_tr_b16 v[232:233], v44 offset:40960
    ds_read_b64_tr_b16 v[234:235], v44 offset:41472
    ds_read_b64_tr_b16 v[236:237], v44 offset:45056
    ds_read_b64_tr_b16 v[238:239], v44 offset:45568
    ds_read_b64_tr_b16 v[240:241], v44 offset:49152
    ds_read_b64_tr_b16 v[242:243], v44 offset:49664
    ds_read_b64_tr_b16 v[244:245], v44 offset:53248
    ds_read_b64_tr_b16 v[246:247], v44 offset:53760
    ds_read_b64_tr_b16 v[248:249], v44 offset:57344
    ds_read_b64_tr_b16 v[250:251], v44 offset:57856
    ds_read_b64_tr_b16 v[252:253], v44 offset:61440
    ds_read_b64_tr_b16 v[254:255], v44 offset:61952
    s_waitcnt lgkmcnt(0)
    s_cmp_lg_u32 s52, 0
    s_cbranch_scc1 L_pol_16
    s_waitcnt vmcnt(0)
L_pl_17c:
    v_subrev_u32 v12, s92, v12
    v_cmp_lt_u32 vcc, 7, v12
    s_cbranch_vccnz L_pl_17r
L_pl_17y:
L_pol_16:
    s_barrier
    s_add_u32 m0, s62, 0
    s_nop 0
    buffer_load_dwordx4 v1, s[40:43], s80 offen offset:0 sc1 lds
    buffer_load_dwordx4 v1, s[40:43], s80 offen offset:1024 sc1 lds
    buffer_load_dwordx4 v1, s[40:43], s80 offen offset:2048 sc1 lds
    buffer_load_dwordx4 v1, s[40:43], s80 offen offset:3072 sc1 lds
    s_add_u32 m0, s62, 16384
    s_nop 0
    buffer_load_dwordx4 v1, s[40:43], s81 offen offset:0 sc1 lds
    buffer_load_dwordx4 v1, s[40:43], s81 offen offset:1024 sc1 lds
    buffer_load_dwordx4 v1, s[40:43], s81 offen offset:2048 sc1 lds
    buffer_load_dwordx4 v1, s[40:43], s81 offen offset:3072 sc1 lds
    s_add_u32 m0, s62, 32768
    s_nop 0
    buffer_load_dwordx4 v1, s[40:43], s82 offen offset:0 sc1 lds
    buffer_load_dwordx4 v1, s[40:43], s82 offen offset:1024 sc1 lds
    buffer_load_dwordx4 v1, s[40:43], s82 offen offset:2048 sc1 lds
    buffer_load_dwordx4 v1, s[40:43], s82 offen offset:3072 sc1 lds
    s_add_u32 m0, s62, 49152
    s_nop 0
    buffer_load_dwordx4 v1, s[40:43], s83 offen offset:0 sc1 lds
    buffer_load_dwordx4 v1, s[40:43], s83 offen offset:1024 sc1 lds
    s_waitcnt vmcnt(10)
    s_barrier
    buffer_load_dwordx4 v1, s[40:43], s83 offen offset:2048 sc1 lds
    buffer_load_dwordx4 v1, s[40:43], s83 offen offset:3072 sc1 lds
    s_waitcnt vmcnt(8)
    s_barrier
    s_mul_i32 s64, s52, 22016
    s_add_u32 s36, s20, s64
    s_addc_u32 s37, s21, 0
    s_sub_u32 s38, 1409024, s64
    s_add_u32 s64, s5, 0
    s_and_b32 s64, s64, 15
    s_mul_i32 s63, s64, 88064
    s_add_u32 m0, s61, 65536
    s_nop 0
    buffer_load_dwordx4 v6, s[36:39], s63 offen offset:0 lds
    buffer_load_dwordx4 v7, s[36:39], s63 offen offset:1024 lds
    buffer_load_dwordx4 v8, s[36:39], s63 offen offset:2048 lds
    s_add_u32 s63, s63, 88064
    s_cmp_ge_u32 s63, 1409024
    s_cselect_b32 s63, 0, s63
    s_add_u32 m0, s61, 77824
    s_nop 0
    buffer_load_dwordx4 v6, s[36:39], s63 offen offset:0 lds
    buffer_load_dwordx4 v7, s[36:39], s63 offen offset:1024 lds
    buffer_load_dwordx4 v8, s[36:39], s63 offen offset:2048 lds
    s_add_u32 s63, s63, 88064
    s_cmp_ge_u32 s63, 1409024
    s_cselect_b32 s63, 0, s63
    s_waitcnt vmcnt(10)
    s_barrier
    s_waitcnt vmcnt(6)
    s_barrier
    s_add_u32 m0, s61, 90112
    s_nop 0
    buffer_load_dwordx4 v6, s[36:39], s63 offen offset:0 lds
    buffer_load_dwordx4 v7, s[36:39], s63 offen offset:1024 lds
    buffer_load_dwordx4 v8, s[36:39], s63 offen offset:2048 lds
    s_add_u32 s63, s63, 88064
    s_cmp_ge_u32 s63, 1409024
    s_cselect_b32 s63, 0, s63
    s_waitcnt vmcnt(6)
    s_add_u32 m0, s61, 102400
    s_nop 0
    buffer_load_dwordx4 v6, s[36:39], s63 offen offset:0 lds
    buffer_load_dwordx4 v7, s[36:39], s63 offen offset:1024 lds
    buffer_load_dwordx4 v8, s[36:39], s63 offen offset:2048 lds
    s_add_u32 s63, s63, 88064
    s_cmp_ge_u32 s63, 1409024
    s_cselect_b32 s63, 0, s63
    s_setprio 0
    v_and_b32 v12, 15, v0
    v_lshrrev_b32 v11, 4, v0
    v_min_u32 v10, 2, v12
    v_lshlrev_b32 v10, 10, v10
    v_lshl_add_u32 v10, v11, 4, v10
    v_add_u32 v10, 147456, v10
    ds_read_b128 v[128:131], v10 offset:0
    ds_read_b128 v[132:135], v10 offset:64
    ds_read_b128 v[136:139], v10 offset:128
    ds_read_b128 v[140:143], v10 offset:192
    ds_read_b128 v[144:147], v10 offset:256
    ds_read_b128 v[148:151], v10 offset:320
    ds_read_b128 v[152:155], v10 offset:384
    ds_read_b128 v[156:159], v10 offset:448
    ds_read_b128 v[160:163], v10 offset:512
    ds_read_b128 v[164:167], v10 offset:576
    ds_read_b128 v[168:171], v10 offset:640
    ds_read_b128 v[172:175], v10 offset:704
    ds_read_b128 v[176:179], v10 offset:768
    ds_read_b128 v[180:183], v10 offset:832
    ds_read_b128 v[184:187], v10 offset:896
    ds_read_b128 v[188:191], v10 offset:960
    v_lshlrev_b32 v13, 4, v12
    v_lshl_add_u32 v2, v11, 12, v13
    v_add_u32 v3, 150528, v13
    s_lshr_b32 s64, s53, 2
    s_add_u32 s64, s64, 1
    s_sub_u32 s65, 0, s64
    s_and_b32 s66, s53, 2
    s_cmp_eq_u32 s66, 0
    s_cselect_b32 s64, s64, s65
    s_mov_b32 s91, 0x140000
    s_cselect_b32 s91, s91, 0xfff40000
    s_cselect_b32 s66, 7, 0
    s_add_u32 s91, s91, s58
    v_lshrrev_b32 v14, 5, v0
    v_lshlrev_b32 v15, 6, v14
    v_lshl_add_u32 v14, v14, 2, s34
    v_lshlrev_b32 v14, 10, v14
    v_and_b32 v11, 1, v11
    v_add_u32 v12, s64, v12
    v_lshl_add_u32 v13, v11, 4, v12
    v_add_u32 v13, 16, v13
    v_lshl_add_u32 v47, v13, 4, v14
    v_mul_u32_u24 v13, 48, v11
    v_add_u32 v13, v13, v12
    v_cmp_gt_u32 vcc, 64, v13
    v_lshl_add_u32 v13, v13, 4, v14
    v_mov_b32 v12, 0x80000000
    v_cndmask_b32_e64 v46, v12, v13, vcc
    v_bfe_u32 v13, v0, 2, 3
    v_cmp_eq_u32 vcc, s66, v13
    v_and_b32 v13, 3, v0
    v_lshl_add_u32 v15, v13, 4, v15
    s_lshl_b32 s65, s90, 6
    v_add_u32 v15, s65, v15
    v_cndmask_b32_e64 v48, v12, v15, vcc
    s_lshr_b32 s64, s52, 1
    s_sub_u32 s65, s64, 1
    s_sub_u32 s66, 63, s64
    s_bitcmp0_b32 s52, 0
    s_cselect_b32 s65, s65, s66
    s_cselect_b32 s66, 0, 31
    v_bfe_u32 v13, v0, 1, 1
    v_add_u32 v13, s65, v13
    v_cmp_gt_u32 s[72:73], 64, v13
    s_lshl_b32 s64, s52, 14
    v_bfe_u32 v12, v0, 2, 2
    v_lshlrev_b32 v12, 12, v12
    v_lshrrev_b32 v15, 4, v0
    v_lshl_add_u32 v12, v15, 10, v12
    v_lshl_add_u32 v12, v13, 4, v12
    v_and_b32 v15, 1, v0
    v_lshl_add_u32 v12, v15, 3, v12
    v_add_u32 v49, s64, v12
    s_lshl_b32 s64, s52, 10
    s_add_u32 s64, s64, s58
    s_add_u32 s78, s64, 0x40000
    s_mov_b32 s70, 0xaaaaaaaa
    s_mov_b32 s71, 0xaaaaaaaa
    s_cmp_eq_u32 s54, s66
    s_cselect_b32 s78, 0x80000000, s78
    s_cmp_eq_u32 s7, 0
    s_cselect_b32 s74, -2, -4
    s_cselect_b32 s76, -4, -2
    s_brev_b32 s75, s74
    s_brev_b32 s77, s76
    s_mov_b32 s68, 0xbdd2d3e8
    s_mov_b32 s69, 0xc0135761
    s_add_u32 s64, s7, s52
    s_add_u32 s64, s64, 0
    s_and_b32 s64, s64, 15
    s_lshl_b32 s64, s64, 12
    s_add_u32 s64, s64, s58
    s_add_u32 s80, s64, 0x0
    s_add_u32 s64, s7, s52
    s_add_u32 s64, s64, 4
    s_and_b32 s64, s64, 15
    s_lshl_b32 s64, s64, 12
    s_add_u32 s64, s64, s58
    s_add_u32 s81, s64, 0x0
    s_add_u32 s64, s7, s52
    s_add_u32 s64, s64, 8
    s_and_b32 s64, s64, 15
    s_lshl_b32 s64, s64, 12
    s_add_u32 s64, s64, s58
    s_add_u32 s82, s64, 0x0
    s_add_u32 s64, s7, s52
    s_add_u32 s64, s64, 12
    s_and_b32 s64, s64, 15
    s_lshl_b32 s64, s64, 12
    s_add_u32 s64, s64, s58
    s_add_u32 s83, s64, 0x0
    s_branch L_pg_18
.p2align 12
L_pg_18:
    s_waitcnt vmcnt(0) lgkmcnt(0)
    s_barrier
    s_setprio 1
    ds_read_b64_tr_b16 v[64:65], v45 offset:0
    v_mfma_f32_16x16x32_bf16 v[12:15], v[128:131], v[128:131], 0
    ds_read_b64_tr_b16 v[66:67], v45 offset:1536
    v_mfma_f32_16x16x32_bf16 v[16:19], v[192:195], v[128:131], 0
    ds_read_b64_tr_b16 v[68:69], v45 offset:128
    v_mfma_f32_16x16x32_bf16 v[12:15], v[132:135], v[132:135], v[12:15]
    ds_read_b64_tr_b16 v[70:71], v45 offset:1664
    v_mfma_f32_16x16x32_bf16 v[16:19], v[196:199], v[132:135], v[16:19]
    ds_read_b64_tr_b16 v[72:73], v45 offset:256
    v_mfma_f32_16x16x32_bf16 v[12:15], v[136:139], v[136:139], v[12:15]
    ds_read_b64_tr_b16 v[74:75], v45 offset:1792
    v_mfma_f32_16x16x32_bf16 v[16:19], v[200:203], v[136:139], v[16:19]
    ds_read_b64_tr_b16 v[76:77], v45 offset:12288
    v_mfma_f32_16x16x32_bf16 v[12:15], v[140:143], v[140:143], v[12:15]
    ds_read_b64_tr_b16 v[78:79], v45 offset:13824
    v_mfma_f32_16x16x32_bf16 v[16:19], v[204:207], v[140:143], v[16:19]
    ds_read_b64_tr_b16 v[80:81], v45 offset:12416
    v_mfma_f32_16x16x32_bf16 v[12:15], v[144:147], v[144:147], v[12:15]
    ds_read_b64_tr_b16 v[82:83], v45 offset:13952
    v_mfma_f32_16x16x32_bf16 v[16:19], v[208:211], v[144:147], v[16:19]
    ds_read_b64_tr_b16 v[84:85], v45 offset:12544
    v_mfma_f32_16x16x32_bf16 v[12:15], v[148:151], v[148:151], v[12:15]
    ds_read_b64_tr_b16 v[86:87], v45 offset:14080
    v_mfma_f32_16x16x32_bf16 v[16:19], v[212:215], v[148:151], v[16:19]
    ds_read_b64_tr_b16 v[88:89], v45 offset:24576
    v_mfma_f32_16x16x32_bf16 v[12:15], v[152:155], v[152:155], v[12:15]
    ds_read_b64_tr_b16 v[90:91], v45 offset:26112
    v_mfma_f32_16x16x32_bf16 v[16:19], v[216:219], v[152:155], v[16:19]
    ds_read_b64_tr_b16 v[92:93], v45 offset:24704
    v_mfma_f32_16x16x32_bf16 v[12:15], v[156:159], v[156:159], v[12:15]
    ds_read_b64_tr_b16 v[94:95], v45 offset:26240
    v_mfma_f32_16x16x32_bf16 v[16:19], v[220:223], v[156:159], v[16:19]
    ds_read_b64_tr_b16 v[96:97], v45 offset:24832
    v_mfma_f32_16x16x32_bf16 v[12:15], v[160:163], v[160:163], v[12:15]
    ds_read_b64_tr_b16 v[98:99], v45 offset:26368
    v_mfma_f32_16x16x32_bf16 v[16:19], v[224:227], v[160:163], v[16:19]
    ds_read_b64_tr_b16 v[100:101], v45 offset:36864
    v_mfma_f32_16x16x32_bf16 v[12:15], v[164:167], v[164:167], v[12:15]
    ds_read_b64_tr_b16 v[102:103], v45 offset:38400
    v_mfma_f32_16x16x32_bf16 v[16:19], v[228:231], v[164:167], v[16:19]
    ds_read_b64_tr_b16 v[104:105], v45 offset:36992
    v_mfma_f32_16x16x32_bf16 v[12:15], v[168:171], v[168:171], v[12:15]
    ds_read_b64_tr_b16 v[106:107], v45 offset:38528
    v_mfma_f32_16x16x32_bf16 v[16:19], v[232:235], v[168:171], v[16:19]
    ds_read_b64_tr_b16 v[108:109], v45 offset:37120
    v_mfma_f32_16x16x32_bf16 v[12:15], v[172:175], v[172:175], v[12:15]
    ds_read_b64_tr_b16 v[110:111], v45 offset:38656
    v_mfma_f32_16x16x32_bf16 v[16:19], v[236:239], v[172:175], v[16:19]
    s_waitcnt vmcnt(0) lgkmcnt(0)
    s_barrier
    v_mfma_f32_16x16x32_bf16 v[12:15], v[176:179], v[176:179], v[12:15]
    v_mfma_f32_16x16x32_bf16 v[16:19], v[240:243], v[176:179], v[16:19]
    v_mfma_f32_16x16x32_bf16 v[12:15], v[180:183], v[180:183], v[12:15]
    v_mfma_f32_16x16x32_bf16 v[16:19], v[244:247], v[180:183], v[16:19]
    v_mfma_f32_16x16x32_bf16 v[12:15], v[184:187], v[184:187], v[12:15]
    v_mfma_f32_16x16x32_bf16 v[16:19], v[248:251], v[184:187], v[16:19]
    v_mfma_f32_16x16x32_bf16 v[12:15], v[188:191], v[188:191], v[12:15]
    v_mfma_f32_16x16x32_bf16 v[16:19], v[252:255], v[188:191], v[16:19]
    v_lshlrev_b32 v10, 3, v0
    v_add_u32 v10, 161856, v10
    s_nop 4
    ds_write_b64 v10, v[12:13]
    v_mov_b32_dpp v20, v16 row_newbcast:0 row_mask:0xf bank_mask:0xf
    v_mov_b32_dpp v24, v16 row_newbcast:1 row_mask:0xf bank_mask:0xf
    v_mov_b32_dpp v28, v16 row_newbcast:2 row_mask:0xf bank_mask:0xf
    v_mov_b32_dpp v21, v17 row_newbcast:0 row_mask:0xf bank_mask:0xf
    v_mov_b32_dpp v25, v17 row_newbcast:1 row_mask:0xf bank_mask:0xf
    v_mov_b32_dpp v29, v17 row_newbcast:2 row_mask:0xf bank_mask:0xf
    v_mov_b32_dpp v22, v18 row_newbcast:0 row_mask:0xf bank_mask:0xf
    v_mov_b32_dpp v26, v18 row_newbcast:1 row_mask:0xf bank_mask:0xf
    v_mov_b32_dpp v30, v18 row_newbcast:2 row_mask:0xf bank_mask:0xf
    v_mov_b32_dpp v23, v19 row_newbcast:0 row_mask:0xf bank_mask:0xf
    v_mov_b32_dpp v27, v19 row_newbcast:1 row_mask:0xf bank_mask:0xf
    v_mov_b32_dpp v31, v19 row_newbcast:2 row_mask:0xf bank_mask:0xf
    s_waitcnt lgkmcnt(0)
    s_barrier
    ds_read_b128 v[144:147], v2 offset:0
    ds_read_b128 v[148:151], v2 offset:256
    ds_read_b128 v[152:155], v2 offset:512
    ds_read_b128 v[156:159], v2 offset:768
    ds_read_b128 v[160:163], v2 offset:1024
    ds_read_b128 v[164:167], v2 offset:1280
    ds_read_b128 v[168:171], v2 offset:1536
    ds_read_b128 v[172:175], v2 offset:1792
    s_waitcnt lgkmcnt(6)
    v_mfma_f32_16x16x32_bf16 v[176:179], v[192:195], v[144:147], 0
    s_barrier
    ds_read_b128 v[144:147], v2 offset:2048
    v_mfma_f32_16x16x32_bf16 v[180:183], v[192:195], v[148:151], 0
    ds_read_b128 v[148:151], v2 offset:2304
    s_waitcnt lgkmcnt(6)
    v_mfma_f32_16x16x32_bf16 v[184:187], v[192:195], v[152:155], 0
    ds_read_b128 v[152:155], v2 offset:2560
    v_mfma_f32_16x16x32_bf16 v[188:191], v[192:195], v[156:159], 0
    ds_read_b128 v[156:159], v2 offset:2816
    s_waitcnt lgkmcnt(6)
    v_mfma_f32_16x16x32_bf16 v[176:179], v[196:199], v[160:163], v[176:179]
    ds_read_b128 v[160:163], v2 offset:3072
    v_mfma_f32_16x16x32_bf16 v[180:183], v[196:199], v[164:167], v[180:183]
    ds_read_b128 v[164:167], v2 offset:3328
    s_waitcnt lgkmcnt(6)
    v_mfma_f32_16x16x32_bf16 v[184:187], v[196:199], v[168:171], v[184:187]
    ds_read_b128 v[168:171], v2 offset:3584
    v_mfma_f32_16x16x32_bf16 v[188:191], v[196:199], v[172:175], v[188:191]
    ds_read_b128 v[172:175], v2 offset:3840
    s_waitcnt lgkmcnt(6)
    v_mfma_f32_16x16x32_bf16 v[176:179], v[200:203], v[144:147], v[176:179]
    s_barrier
    ds_read_b128 v[144:147], v2 offset:16384
    v_mfma_f32_16x16x32_bf16 v[180:183], v[200:203], v[148:151], v[180:183]
    ds_read_b128 v[148:151], v2 offset:16640
    s_waitcnt lgkmcnt(6)
    v_mfma_f32_16x16x32_bf16 v[184:187], v[200:203], v[152:155], v[184:187]
    ds_read_b128 v[152:155], v2 offset:16896
    v_mfma_f32_16x16x32_bf16 v[188:191], v[200:203], v[156:159], v[188:191]
    ds_read_b128 v[156:159], v2 offset:17152
    s_waitcnt lgkmcnt(6)
    v_mfma_f32_16x16x32_bf16 v[176:179], v[204:207], v[160:163], v[176:179]
    ds_read_b128 v[160:163], v2 offset:17408
    v_mfma_f32_16x16x32_bf16 v[180:183], v[204:207], v[164:167], v[180:183]
    ds_read_b128 v[164:167], v2 offset:17664
    s_waitcnt lgkmcnt(6)
    v_mfma_f32_16x16x32_bf16 v[184:187], v[204:207], v[168:171], v[184:187]
    ds_read_b128 v[168:171], v2 offset:17920
    v_mfma_f32_16x16x32_bf16 v[188:191], v[204:207], v[172:175], v[188:191]
    ds_read_b128 v[172:175], v2 offset:18176
    s_waitcnt lgkmcnt(6)
    v_mfma_f32_16x16x32_bf16 v[176:179], v[208:211], v[144:147], v[176:179]
    ds_read_b128 v[144:147], v2 offset:18432
    v_mfma_f32_16x16x32_bf16 v[180:183], v[208:211], v[148:151], v[180:183]
    ds_read_b128 v[148:151], v2 offset:18688
    s_waitcnt lgkmcnt(6)
    v_mfma_f32_16x16x32_bf16 v[184:187], v[208:211], v[152:155], v[184:187]
    ds_read_b128 v[152:155], v2 offset:18944
    v_mfma_f32_16x16x32_bf16 v[188:191], v[208:211], v[156:159], v[188:191]
    ds_read_b128 v[156:159], v2 offset:19200
    s_waitcnt lgkmcnt(6)
    v_mfma_f32_16x16x32_bf16 v[176:179], v[212:215], v[160:163], v[176:179]
    ds_read_b128 v[160:163], v2 offset:19456
    v_mfma_f32_16x16x32_bf16 v[180:183], v[212:215], v[164:167], v[180:183]
    ds_read_b128 v[164:167], v2 offset:19712
    s_waitcnt lgkmcnt(6)
    v_mfma_f32_16x16x32_bf16 v[184:187], v[212:215], v[168:171], v[184:187]
    ds_read_b128 v[168:171], v2 offset:19968
    v_mfma_f32_16x16x32_bf16 v[188:191], v[212:215], v[172:175], v[188:191]
    ds_read_b128 v[172:175], v2 offset:20224
    s_waitcnt lgkmcnt(6)
    v_mfma_f32_16x16x32_bf16 v[176:179], v[216:219], v[144:147], v[176:179]
    s_barrier
    ds_read_b128 v[144:147], v2 offset:32768
    v_mfma_f32_16x16x32_bf16 v[180:183], v[216:219], v[148:151], v[180:183]
    ds_read_b128 v[148:151], v2 offset:33024
    s_waitcnt lgkmcnt(6)
    v_mfma_f32_16x16x32_bf16 v[184:187], v[216:219], v[152:155], v[184:187]
    ds_read_b128 v[152:155], v2 offset:33280
    v_mfma_f32_16x16x32_bf16 v[188:191], v[216:219], v[156:159], v[188:191]
    ds_read_b128 v[156:159], v2 offset:33536
    s_waitcnt lgkmcnt(6)
    v_mfma_f32_16x16x32_bf16 v[176:179], v[220:223], v[160:163], v[176:179]
    ds_read_b128 v[160:163], v2 offset:33792
    v_mfma_f32_16x16x32_bf16 v[180:183], v[220:223], v[164:167], v[180:183]
    ds_read_b128 v[164:167], v2 offset:34048
    s_waitcnt lgkmcnt(6)
    v_mfma_f32_16x16x32_bf16 v[184:187], v[220:223], v[168:171], v[184:187]
    ds_read_b128 v[168:171], v2 offset:34304
    v_mfma_f32_16x16x32_bf16 v[188:191], v[220:223], v[172:175], v[188:191]
    ds_read_b128 v[172:175], v2 offset:34560
    s_waitcnt lgkmcnt(6)
    v_mfma_f32_16x16x32_bf16 v[176:179], v[224:227], v[144:147], v[176:179]
    ds_read_b128 v[144:147], v2 offset:34816
    v_mfma_f32_16x16x32_bf16 v[180:183], v[224:227], v[148:151], v[180:183]
    ds_read_b128 v[148:151], v2 offset:35072
    s_waitcnt lgkmcnt(6)
    v_mfma_f32_16x16x32_bf16 v[184:187], v[224:227], v[152:155], v[184:187]
    ds_read_b128 v[152:155], v2 offset:35328
    v_mfma_f32_16x16x32_bf16 v[188:191], v[224:227], v[156:159], v[188:191]
    ds_read_b128 v[156:159], v2 offset:35584
    s_waitcnt lgkmcnt(6)
    v_mfma_f32_16x16x32_bf16 v[176:179], v[228:231], v[160:163], v[176:179]
    ds_read_b128 v[160:163], v2 offset:35840
    v_mfma_f32_16x16x32_bf16 v[180:183], v[228:231], v[164:167], v[180:183]
    ds_read_b128 v[164:167], v2 offset:36096
    s_waitcnt lgkmcnt(6)
    v_mfma_f32_16x16x32_bf16 v[184:187], v[228:231], v[168:171], v[184:187]
    ds_read_b128 v[168:171], v2 offset:36352
    v_mfma_f32_16x16x32_bf16 v[188:191], v[228:231], v[172:175], v[188:191]
    ds_read_b128 v[172:175], v2 offset:36608
    s_waitcnt lgkmcnt(6)
    v_mfma_f32_16x16x32_bf16 v[176:179], v[232:235], v[144:147], v[176:179]
    s_barrier
    ds_read_b128 v[144:147], v2 offset:49152
    v_mfma_f32_16x16x32_bf16 v[180:183], v[232:235], v[148:151], v[180:183]
    ds_read_b128 v[148:151], v2 offset:49408
    s_waitcnt lgkmcnt(6)
    v_mfma_f32_16x16x32_bf16 v[184:187], v[232:235], v[152:155], v[184:187]
    ds_read_b128 v[152:155], v2 offset:49664
    v_mfma_f32_16x16x32_bf16 v[188:191], v[232:235], v[156:159], v[188:191]
    ds_read_b128 v[156:159], v2 offset:49920
    s_waitcnt lgkmcnt(6)
    v_mfma_f32_16x16x32_bf16 v[176:179], v[236:239], v[160:163], v[176:179]
    ds_read_b128 v[160:163], v2 offset:50176
    v_mfma_f32_16x16x32_bf16 v[180:183], v[236:239], v[164:167], v[180:183]
    ds_read_b128 v[164:167], v2 offset:50432
    s_waitcnt lgkmcnt(6)
    v_mfma_f32_16x16x32_bf16 v[184:187], v[236:239], v[168:171], v[184:187]
    ds_read_b128 v[168:171], v2 offset:50688
    v_mfma_f32_16x16x32_bf16 v[188:191], v[236:239], v[172:175], v[188:191]
    ds_read_b128 v[172:175], v2 offset:50944
    s_waitcnt lgkmcnt(6)
    v_mfma_f32_16x16x32_bf16 v[176:179], v[240:243], v[144:147], v[176:179]
    ds_read_b128 v[144:147], v2 offset:51200
    v_mfma_f32_16x16x32_bf16 v[180:183], v[240:243], v[148:151], v[180:183]
    ds_read_b128 v[148:151], v2 offset:51456
    s_waitcnt lgkmcnt(6)
    v_mfma_f32_16x16x32_bf16 v[184:187], v[240:243], v[152:155], v[184:187]
    ds_read_b128 v[152:155], v2 offset:51712
    v_mfma_f32_16x16x32_bf16 v[188:191], v[240:243], v[156:159], v[188:191]
    ds_read_b128 v[156:159], v2 offset:51968
    s_waitcnt lgkmcnt(6)
    v_mfma_f32_16x16x32_bf16 v[176:179], v[244:247], v[160:163], v[176:179]
    ds_read_b128 v[160:163], v2 offset:52224
    v_mfma_f32_16x16x32_bf16 v[180:183], v[244:247], v[164:167], v[180:183]
    ds_read_b128 v[164:167], v2 offset:52480
    s_waitcnt lgkmcnt(6)
    v_mfma_f32_16x16x32_bf16 v[184:187], v[244:247], v[168:171], v[184:187]
    ds_read_b128 v[168:171], v2 offset:52736
    v_mfma_f32_16x16x32_bf16 v[188:191], v[244:247], v[172:175], v[188:191]
    ds_read_b128 v[172:175], v2 offset:52992
    s_waitcnt lgkmcnt(6)
    v_mfma_f32_16x16x32_bf16 v[176:179], v[248:251], v[144:147], v[176:179]
    v_mfma_f32_16x16x32_bf16 v[180:183], v[248:251], v[148:151], v[180:183]
    s_waitcnt lgkmcnt(4)
    v_mfma_f32_16x16x32_bf16 v[184:187], v[248:251], v[152:155], v[184:187]
    v_mfma_f32_16x16x32_bf16 v[188:191], v[248:251], v[156:159], v[188:191]
    s_waitcnt lgkmcnt(2)
    v_mfma_f32_16x16x32_bf16 v[176:179], v[252:255], v[160:163], v[176:179]
    v_mfma_f32_16x16x32_bf16 v[180:183], v[252:255], v[164:167], v[180:183]
    s_waitcnt lgkmcnt(0)
    v_mfma_f32_16x16x32_bf16 v[184:187], v[252:255], v[168:171], v[184:187]
    v_mfma_f32_16x16x32_bf16 v[188:191], v[252:255], v[172:175], v[188:191]
    s_setprio 3
    s_barrier
    ds_read_b128 v[128:131], v3 offset:0
    ds_read_b128 v[132:135], v3 offset:256
    ds_read_b128 v[136:139], v3 offset:512
    ds_read_b128 v[140:143], v3 offset:768
    s_waitcnt lgkmcnt(0)
    v_pk_mul_f32 v[176:177], v[176:177], v[128:129] op_sel_hi:[1,0]
    v_pk_mul_f32 v[178:179], v[178:179], v[128:129] op_sel_hi:[1,0]
    v_pk_mul_f32 v[188:189], v[188:189], v[140:141] op_sel_hi:[1,0]
    v_pk_mul_f32 v[190:191], v[190:191], v[140:141] op_sel_hi:[1,0]
    v_pk_fma_f32 v[176:177], v[20:21], v[128:129], v[176:177] op_sel:[0,1,0] op_sel_hi:[1,1,1]
    v_pk_fma_f32 v[178:179], v[22:23], v[128:129], v[178:179] op_sel:[0,1,0] op_sel_hi:[1,1,1]
    v_pk_fma_f32 v[188:189], v[20:21], v[140:141], v[188:189] op_sel:[0,1,0] op_sel_hi:[1,1,1]
    v_pk_fma_f32 v[190:191], v[22:23], v[140:141], v[190:191] op_sel:[0,1,0] op_sel_hi:[1,1,1]
    v_pk_fma_f32 v[176:177], v[24:25], v[130:131], v[176:177] op_sel_hi:[1,0,1]
    v_pk_fma_f32 v[178:179], v[26:27], v[130:131], v[178:179] op_sel_hi:[1,0,1]
    v_pk_fma_f32 v[188:189], v[24:25], v[142:143], v[188:189] op_sel_hi:[1,0,1]
    v_pk_fma_f32 v[190:191], v[26:27], v[142:143], v[190:191] op_sel_hi:[1,0,1]
    v_pk_fma_f32 v[176:177], v[28:29], v[130:131], v[176:177] op_sel:[0,1,0] op_sel_hi:[1,1,1]
    v_pk_fma_f32 v[178:179], v[30:31], v[130:131], v[178:179] op_sel:[0,1,0] op_sel_hi:[1,1,1]
    v_pk_fma_f32 v[188:189], v[28:29], v[142:143], v[188:189] op_sel:[0,1,0] op_sel_hi:[1,1,1]
    v_pk_fma_f32 v[190:191], v[30:31], v[142:143], v[190:191] op_sel:[0,1,0] op_sel_hi:[1,1,1]
    v_pk_mul_f32 v[160:161], v[176:177], v[176:177]
    v_pk_mul_f32 v[162:163], v[178:179], v[178:179]
    v_pk_mul_f32 v[164:165], v[188:189], v[188:189]
    v_pk_mul_f32 v[166:167], v[190:191], v[190:191]
    v_pk_fma_f32 v[160:161], v[160:161], s[68:69], s[68:69] op_sel:[0,0,1] op_sel_hi:[1,0,1]
    v_pk_fma_f32 v[162:163], v[162:163], s[68:69], s[68:69] op_sel:[0,0,1] op_sel_hi:[1,0,1]
    v_pk_fma_f32 v[164:165], v[164:165], s[68:69], s[68:69] op_sel:[0,0,1] op_sel_hi:[1,0,1]
    v_pk_fma_f32 v[166:167], v[166:167], s[68:69], s[68:69] op_sel:[0,0,1] op_sel_hi:[1,0,1]
    v_pk_mul_f32 v[160:161], v[160:161], v[176:177]
    v_pk_mul_f32 v[162:163], v[162:163], v[178:179]
    v_pk_mul_f32 v[164:165], v[164:165], v[188:189]
    v_pk_mul_f32 v[166:167], v[166:167], v[190:191]
    v_exp_f32 v160, v160
    v_exp_f32 v161, v161
    v_exp_f32 v162, v162
    v_exp_f32 v163, v163
    v_exp_f32 v164, v164
    v_exp_f32 v165, v165
    v_exp_f32 v166, v166
    v_exp_f32 v167, v167
    v_pk_add_f32 v[160:161], v[160:161], 1.0 op_sel_hi:[1,0]
    v_pk_add_f32 v[162:163], v[162:163], 1.0 op_sel_hi:[1,0]
    v_pk_add_f32 v[164:165], v[164:165], 1.0 op_sel_hi:[1,0]
    v_pk_add_f32 v[166:167], v[166:167], 1.0 op_sel_hi:[1,0]
    v_rcp_f32 v160, v160
    v_rcp_f32 v161, v161
    v_rcp_f32 v162, v162
    v_rcp_f32 v163, v163
    v_rcp_f32 v164, v164
    v_rcp_f32 v165, v165
    v_rcp_f32 v166, v166
    v_rcp_f32 v167, v167
    v_pk_mul_f32 v[160:161], v[160:161], v[176:177]
    v_pk_mul_f32 v[162:163], v[162:163], v[178:179]
    v_pk_mul_f32 v[164:165], v[164:165], v[188:189]
    v_pk_mul_f32 v[166:167], v[166:167], v[190:191]
    v_cvt_pk_bf16_f32 v12, v160, v161
    v_cvt_pk_bf16_f32 v13, v162, v163
    v_cvt_pk_bf16_f32 v14, v164, v165
    v_cvt_pk_bf16_f32 v15, v166, v167
    s_nop 0
    v_permlane16_swap_b32 v12, v14
    v_permlane16_swap_b32 v13, v15
    s_bitcmp0_b32 s53, 1
    v_mov_b32 v146, s56
    v_mov_b32 v147, s56
    s_cbranch_scc1 L_hq_19a
    v_mov_b32_dpp v148, v12 quad_perm:[0,0,1,1] row_mask:0xf bank_mask:0xf
    v_mov_b32_dpp v149, v13 quad_perm:[0,0,1,1] row_mask:0xf bank_mask:0xf
    v_mov_b32_dpp v150, v14 quad_perm:[0,0,1,1] row_mask:0xf bank_mask:0xf
    v_mov_b32_dpp v151, v15 quad_perm:[0,0,1,1] row_mask:0xf bank_mask:0xf
    s_branch L_hq_19b
L_hq_19a:
    v_mov_b32_dpp v148, v12 quad_perm:[2,2,3,3] row_mask:0xf bank_mask:0xf
    v_mov_b32_dpp v149, v13 quad_perm:[2,2,3,3] row_mask:0xf bank_mask:0xf
    v_mov_b32_dpp v150, v14 quad_perm:[2,2,3,3] row_mask:0xf bank_mask:0xf
    v_mov_b32_dpp v151, v15 quad_perm:[2,2,3,3] row_mask:0xf bank_mask:0xf
L_hq_19b:
    v_cndmask_b32 v144, v148, v150, s[70:71]
    v_cndmask_b32 v145, v149, v151, s[70:71]
    buffer_store_dwordx4 v[144:147], v48, s[40:43], s91 offen sc1
    s_cmp_eq_u32 s57, 0
    s_cbranch_scc1 L_st_20s
    buffer_store_dwordx4 v[12:15], v46, s[40:43], s58 offen
L_st_20e:
    v_pk_mul_f32 v[180:181], v[180:181], v[132:133] op_sel_hi:[1,0]
    v_pk_mul_f32 v[182:183], v[182:183], v[132:133] op_sel_hi:[1,0]
    v_pk_mul_f32 v[184:185], v[184:185], v[136:137] op_sel_hi:[1,0]
    v_pk_mul_f32 v[186:187], v[186:187], v[136:137] op_sel_hi:[1,0]
    v_pk_fma_f32 v[180:181], v[20:21], v[132:133], v[180:181] op_sel:[0,1,0] op_sel_hi:[1,1,1]
    v_pk_fma_f32 v[182:183], v[22:23], v[132:133], v[182:183] op_sel:[0,1,0] op_sel_hi:[1,1,1]
    v_pk_fma_f32 v[184:185], v[20:21], v[136:137], v[184:185] op_sel:[0,1,0] op_sel_hi:[1,1,1]
    v_pk_fma_f32 v[186:187], v[22:23], v[136:137], v[186:187] op_sel:[0,1,0] op_sel_hi:[1,1,1]
    v_pk_fma_f32 v[180:181], v[24:25], v[134:135], v[180:181] op_sel_hi:[1,0,1]
    v_pk_fma_f32 v[182:183], v[26:27], v[134:135], v[182:183] op_sel_hi:[1,0,1]
    v_pk_fma_f32 v[184:185], v[24:25], v[138:139], v[184:185] op_sel_hi:[1,0,1]
    v_pk_fma_f32 v[186:187], v[26:27], v[138:139], v[186:187] op_sel_hi:[1,0,1]
    v_pk_fma_f32 v[180:181], v[28:29], v[134:135], v[180:181] op_sel:[0,1,0] op_sel_hi:[1,1,1]
    v_pk_fma_f32 v[182:183], v[30:31], v[134:135], v[182:183] op_sel:[0,1,0] op_sel_hi:[1,1,1]
    v_pk_fma_f32 v[184:185], v[28:29], v[138:139], v[184:185] op_sel:[0,1,0] op_sel_hi:[1,1,1]
    v_pk_fma_f32 v[186:187], v[30:31], v[138:139], v[186:187] op_sel:[0,1,0] op_sel_hi:[1,1,1]
    v_pk_mul_f32 v[160:161], v[180:181], v[180:181]
    v_pk_mul_f32 v[162:163], v[182:183], v[182:183]
    v_pk_mul_f32 v[164:165], v[184:185], v[184:185]
    v_pk_mul_f32 v[166:167], v[186:187], v[186:187]
    v_pk_fma_f32 v[160:161], v[160:161], s[68:69], s[68:69] op_sel:[0,0,1] op_sel_hi:[1,0,1]
    v_pk_fma_f32 v[162:163], v[162:163], s[68:69], s[68:69] op_sel:[0,0,1] op_sel_hi:[1,0,1]
    v_pk_fma_f32 v[164:165], v[164:165], s[68:69], s[68:69] op_sel:[0,0,1] op_sel_hi:[1,0,1]
    v_pk_fma_f32 v[166:167], v[166:167], s[68:69], s[68:69] op_sel:[0,0,1] op_sel_hi:[1,0,1]
    v_pk_mul_f32 v[160:161], v[160:161], v[180:181]
    v_pk_mul_f32 v[162:163], v[162:163], v[182:183]
    v_pk_mul_f32 v[164:165], v[164:165], v[184:185]
    v_pk_mul_f32 v[166:167], v[166:167], v[186:187]
    v_exp_f32 v160, v160
    v_exp_f32 v161, v161
    v_exp_f32 v162, v162
    v_exp_f32 v163, v163
    v_exp_f32 v164, v164
    v_exp_f32 v165, v165
    v_exp_f32 v166, v166
    v_exp_f32 v167, v167
    v_pk_add_f32 v[160:161], v[160:161], 1.0 op_sel_hi:[1,0]
    v_pk_add_f32 v[162:163], v[162:163], 1.0 op_sel_hi:[1,0]
    v_pk_add_f32 v[164:165], v[164:165], 1.0 op_sel_hi:[1,0]
    v_pk_add_f32 v[166:167], v[166:167], 1.0 op_sel_hi:[1,0]
    v_rcp_f32 v160, v160
    v_rcp_f32 v161, v161
    v_rcp_f32 v162, v162
    v_rcp_f32 v163, v163
    v_rcp_f32 v164, v164
    v_rcp_f32 v165, v165
    v_rcp_f32 v166, v166
    v_rcp_f32 v167, v167
    v_pk_mul_f32 v[160:161], v[160:161], v[180:181]
    v_pk_mul_f32 v[162:163], v[162:163], v[182:183]
    v_pk_mul_f32 v[164:165], v[164:165], v[184:185]
    v_pk_mul_f32 v[166:167], v[166:167], v[186:187]
    v_cvt_pk_bf16_f32 v16, v160, v161
    v_cvt_pk_bf16_f32 v17, v162, v163
    v_cvt_pk_bf16_f32 v18, v164, v165
    v_cvt_pk_bf16_f32 v19, v166, v167
    s_nop 0
    v_permlane16_swap_b32 v16, v18
    v_permlane16_swap_b32 v17, v19
    s_cmp_eq_u32 s57, 0
    s_cbranch_scc1 L_st_21s
    buffer_store_dwordx4 v[16:19], v47, s[40:43], s58 offen
L_st_21e:
    s_lshl_b32 s64, s53, 2
    v_mov_b32 v20, s64
    s_add_u32 s92, s56, 4
    v_mov_b32 v21, s92
    v_and_b32 v23, 7, v0
    v_lshlrev_b32 v23, 2, v23
    s_waitcnt vmcnt(0) lgkmcnt(0)
    s_barrier
    s_setprio 2
    s_cmp_lg_u32 s52, 0
    s_cbranch_scc1 L_pub_22n
    s_cmp_eq_u32 s57, 0
    s_cbranch_scc1 L_st_23s
    buffer_store_dword v21, v20, s[40:43], s93 offen
L_st_23e:
L_pub_22n:
    ds_read_b64_tr_b16 v[112:113], v45 offset:0
    ds_read_b64_tr_b16 v[114:115], v45 offset:1536
    ds_read_b64_tr_b16 v[116:117], v45 offset:128
    ds_read_b64_tr_b16 v[118:119], v45 offset:1664
    ds_read_b64_tr_b16 v[120:121], v45 offset:256
    ds_read_b64_tr_b16 v[122:123], v45 offset:1792
    ds_read_b64_tr_b16 v[124:125], v45 offset:12288
    ds_read_b64_tr_b16 v[126:127], v45 offset:13824
    ds_read_b64_tr_b16 v[128:129], v45 offset:12416
    ds_read_b64_tr_b16 v[130:131], v45 offset:13952
    ds_read_b64_tr_b16 v[132:133], v45 offset:12544
    ds_read_b64_tr_b16 v[134:135], v45 offset:14080
    s_cmp_lg_u32 s52, 0
    s_cbranch_scc1 L_pol_24
    buffer_load_dword v22, v23, s[40:43], s93 offen sc1
L_pol_24:
    buffer_load_dwordx4 v[24:27], v1, s[40:43], s78 offen sc1
    ds_read_b64_tr_b16 v[136:137], v45 offset:24576
    v_mfma_f32_16x16x32_bf16 v[32:35], v[50:53], v[64:67], 0
    ds_read_b64_tr_b16 v[138:139], v45 offset:26112
    ds_read_b64_tr_b16 v[140:141], v45 offset:24704
    v_mfma_f32_16x16x32_bf16 v[36:39], v[50:53], v[68:71], 0
    ds_read_b64_tr_b16 v[142:143], v45 offset:26240
    ds_read_b64_tr_b16 v[144:145], v45 offset:24832
    v_mfma_f32_16x16x32_bf16 v[40:43], v[50:53], v[72:75], 0
    ds_read_b64_tr_b16 v[146:147], v45 offset:26368
    ds_read_b64_tr_b16 v[148:149], v45 offset:36864
    v_mfma_f32_16x16x32_bf16 v[32:35], v[50:53], v[76:79], v[32:35]
    ds_read_b64_tr_b16 v[150:151], v45 offset:38400
    ds_read_b64_tr_b16 v[152:153], v45 offset:36992
    v_mfma_f32_16x16x32_bf16 v[36:39], v[50:53], v[80:83], v[36:39]
    ds_read_b64_tr_b16 v[154:155], v45 offset:38528
    ds_read_b64_tr_b16 v[156:157], v45 offset:37120
    v_mfma_f32_16x16x32_bf16 v[40:43], v[50:53], v[84:87], v[40:43]
    ds_read_b64_tr_b16 v[158:159], v45 offset:38656
    ds_read_b64_tr_b16 v[160:161], v45 offset:49152
    v_mfma_f32_16x16x32_bf16 v[32:35], v[50:53], v[88:91], v[32:35]
    ds_read_b64_tr_b16 v[162:163], v45 offset:50688
    ds_read_b64_tr_b16 v[164:165], v45 offset:49280
    v_mfma_f32_16x16x32_bf16 v[36:39], v[50:53], v[92:95], v[36:39]
    ds_read_b64_tr_b16 v[166:167], v45 offset:50816
    ds_read_b64_tr_b16 v[168:169], v45 offset:49408
    v_mfma_f32_16x16x32_bf16 v[40:43], v[50:53], v[96:99], v[40:43]
    ds_read_b64_tr_b16 v[170:171], v45 offset:50944
    ds_read_b64_tr_b16 v[172:173], v45 offset:61440
    v_mfma_f32_16x16x32_bf16 v[32:35], v[50:53], v[100:103], v[32:35]
    ds_read_b64_tr_b16 v[174:175], v45 offset:62976
    ds_read_b64_tr_b16 v[176:177], v45 offset:61568
    v_mfma_f32_16x16x32_bf16 v[36:39], v[50:53], v[104:107], v[36:39]
    ds_read_b64_tr_b16 v[178:179], v45 offset:63104
    ds_read_b64_tr_b16 v[180:181], v45 offset:61696
    v_mfma_f32_16x16x32_bf16 v[40:43], v[50:53], v[108:111], v[40:43]
    ds_read_b64_tr_b16 v[182:183], v45 offset:63232
    s_waitcnt lgkmcnt(0)
    s_cmp_lg_u32 s52, 0
    s_cbranch_scc1 L_pol_25
    s_waitcnt vmcnt(1)
L_pl_26c:
    v_subrev_u32 v22, s92, v22
    v_cmp_lt_u32 vcc, 7, v22
    s_cbranch_vccnz L_pl_26r
L_pl_26y:
L_pol_25:
    s_barrier
    s_add_u32 m0, s62, 0
    s_mov_b32 exec_lo, s74
    buffer_load_dwordx4 v1, s[40:43], s80 offen offset:0 sc1 lds
    buffer_load_dwordx4 v1, s[40:43], s80 offen offset:1024 sc1 lds
    buffer_load_dwordx4 v1, s[40:43], s80 offen offset:2048 sc1 lds
    buffer_load_dwordx4 v1, s[40:43], s80 offen offset:3072 sc1 lds
    s_mov_b32 exec_lo, -1
    s_add_u32 m0, s62, 16384
    s_mov_b32 exec_hi, s75
    buffer_load_dwordx4 v1, s[40:43], s81 offen offset:0 sc1 lds
    buffer_load_dwordx4 v1, s[40:43], s81 offen offset:1024 sc1 lds
    s_waitcnt vmcnt(4)
    s_barrier
    buffer_load_dwordx4 v1, s[40:43], s81 offen offset:2048 sc1 lds
    buffer_load_dwordx4 v1, s[40:43], s81 offen offset:3072 sc1 lds
    s_mov_b32 exec_hi, -1
    s_waitcnt vmcnt(4)
    s_barrier
    s_waitcnt vmcnt(8)
    s_cmp_eq_u32 s78, 0x80000000
    s_cbranch_scc1 L_hl_27
L_pl_28c:
    v_cmp_ne_u32 vcc, s56, v26
    s_cbranch_vccnz L_pl_28r
L_pl_28y:
L_hl_27:
    s_mov_b64 exec, s[72:73]
    ds_write_b64 v49, v[24:25]
    s_mov_b64 exec, -1
    s_add_u32 m0, s62, 32768
    s_mov_b32 exec_lo, s76
    buffer_load_dwordx4 v1, s[40:43], s82 offen offset:0 sc1 lds
    buffer_load_dwordx4 v1, s[40:43], s82 offen offset:1024 sc1 lds
    buffer_load_dwordx4 v1, s[40:43], s82 offen offset:2048 sc1 lds
    buffer_load_dwordx4 v1, s[40:43], s82 offen offset:3072 sc1 lds
    s_mov_b32 exec_lo, -1
    s_waitcnt lgkmcnt(0)
    s_waitcnt vmcnt(4)
    s_barrier
    s_add_u32 m0, s62, 49152
    s_mov_b32 exec_hi, s77
    buffer_load_dwordx4 v1, s[40:43], s83 offen offset:0 sc1 lds
    buffer_load_dwordx4 v1, s[40:43], s83 offen offset:1024 sc1 lds
    buffer_load_dwordx4 v1, s[40:43], s83 offen offset:2048 sc1 lds
    buffer_load_dwordx4 v1, s[40:43], s83 offen offset:3072 sc1 lds
    s_mov_b32 exec_hi, -1
    s_waitcnt vmcnt(4)
    s_barrier
    s_mul_i32 s64, s52, 22016
    s_add_u32 s36, s20, s64
    s_addc_u32 s37, s21, 0
    s_sub_u32 s38, 1409024, s64
    s_add_u32 s64, s5, 10
    s_and_b32 s64, s64, 15
    s_mul_i32 s63, s64, 88064
    s_add_u32 m0, s61, 65536
    s_nop 0
    buffer_load_dwordx4 v6, s[36:39], s63 offen offset:0 lds
    buffer_load_dwordx4 v7, s[36:39], s63 offen offset:1024 lds
    buffer_load_dwordx4 v8, s[36:39], s63 offen offset:2048 lds
    s_add_u32 s63, s63, 88064
    s_cmp_ge_u32 s63, 1409024
    s_cselect_b32 s63, 0, s63
    s_waitcnt lgkmcnt(0)
    s_waitcnt vmcnt(3)
    s_barrier
    s_add_u32 m0, s61, 77824
    s_nop 0
    buffer_load_dwordx4 v6, s[36:39], s63 offen offset:0 lds
    buffer_load_dwordx4 v7, s[36:39], s63 offen offset:1024 lds
    buffer_load_dwordx4 v8, s[36:39], s63 offen offset:2048 lds
    s_add_u32 s63, s63, 88064
    s_cmp_ge_u32 s63, 1409024
    s_cselect_b32 s63, 0, s63
    s_add_u32 m0, s61, 90112
    s_nop 0
    buffer_load_dwordx4 v6, s[36:39], s63 offen offset:0 lds
    buffer_load_dwordx4 v7, s[36:39], s63 offen offset:1024 lds
    buffer_load_dwordx4 v8, s[36:39], s63 offen offset:2048 lds
    s_add_u32 s63, s63, 88064
    s_cmp_ge_u32 s63, 1409024
    s_cselect_b32 s63, 0, s63
    s_waitcnt vmcnt(6)
    s_add_u32 m0, s61, 102400
    s_nop 0
    buffer_load_dwordx4 v6, s[36:39], s63 offen offset:0 lds
    buffer_load_dwordx4 v7, s[36:39], s63 offen offset:1024 lds
    buffer_load_dwordx4 v8, s[36:39], s63 offen offset:2048 lds
    s_add_u32 s63, s63, 88064
    s_cmp_ge_u32 s63, 1409024
    s_cselect_b32 s63, 0, s63
    s_waitcnt vmcnt(6)
    s_add_u32 m0, s61, 114688
    s_nop 0
    buffer_load_dwordx4 v6, s[36:39], s63 offen offset:0 lds
    buffer_load_dwordx4 v7, s[36:39], s63 offen offset:1024 lds
    buffer_load_dwordx4 v8, s[36:39], s63 offen offset:2048 lds
    s_add_u32 s63, s63, 88064
    s_cmp_ge_u32 s63, 1409024
    s_cselect_b32 s63, 0, s63
    s_waitcnt vmcnt(6)
    s_add_u32 m0, s61, 126976
    s_nop 0
    buffer_load_dwordx4 v6, s[36:39], s63 offen offset:0 lds
    buffer_load_dwordx4 v7, s[36:39], s63 offen offset:1024 lds
    buffer_load_dwordx4 v8, s[36:39], s63 offen offset:2048 lds
    s_add_u32 s63, s63, 88064
    s_cmp_ge_u32 s63, 1409024
    s_cselect_b32 s63, 0, s63
    s_setprio 0
    s_min_u32 s70, s53, 3
    s_mul_i32 s71, s53, 5
    s_add_u32 s70, s70, s71
    s_lshl_b32 s70, s70, 2
    s_lshl_b32 s71, s52, 1
    s_add_u32 s70, s70, s71
    v_lshrrev_b32 v10, 5, v0
    v_lshlrev_b32 v10, 12, v10
    v_and_b32 v4, 31, v0
    v_lshl_add_u32 v4, v4, 4, v10
    s_and_b32 s64, s70, 3
    s_lshl_b32 s64, s64, 2
    s_bfe_u32 s65, s70, 0x20002
    s_or_b32 s64, s64, s65
    s_andn2_b32 s80, s70, 15
    s_or_b32 s80, s80, s64
    s_lshl_b32 s80, s80, 10
    s_add_u32 s80, s80, s58
    s_add_u32 s70, s70, 8
    s_and_b32 s64, s70, 3
    s_lshl_b32 s64, s64, 2
    s_bfe_u32 s65, s70, 0x20002
    s_or_b32 s64, s64, s65
    s_andn2_b32 s81, s70, 15
    s_or_b32 s81, s81, s64
    s_lshl_b32 s81, s81, 10
    s_add_u32 s81, s81, s58
    s_add_u32 s70, s70, 8
    s_and_b32 s64, s70, 3
    s_lshl_b32 s64, s64, 2
    s_bfe_u32 s65, s70, 0x20002
    s_or_b32 s64, s64, s65
    s_andn2_b32 s82, s70, 15
    s_or_b32 s82, s82, s64
    s_lshl_b32 s82, s82, 10
    s_add_u32 s82, s82, s58
    s_add_u32 s70, s70, 8
    s_cmp_lt_u32 s53, 3
    s_cselect_b32 s70, 4, 2
    s_cmp_lt_u32 s52, s70
    s_cselect_b32 s70, 0, 0x80000000
    v_add_u32 v3, 1536, v3
    s_or_b32 s82, s82, s70
    v_lshrrev_b32 v2, 4, v0
    v_lshlrev_b32 v2, 4, v2
    s_mul_i32 s70, s52, 192
    s_add_u32 s70, s70, 162816
    v_add_u32 v2, s70, v2
    v_and_b32 v14, 15, v0
    v_lshl_add_u32 v14, v14, 2, s70
    s_add_u32 s68, s58, s62
    s_add_u32 s69, s68, 16384
    s_add_u32 s70, s68, 32768
    s_add_u32 s71, s68, 49152
    s_add_u32 s72, s68, 65536
    s_add_u32 s73, s68, 81920
    s_add_u32 s74, s68, 98304
    s_add_u32 s75, s68, 114688
    s_add_u32 s76, s68, 131072
    s_add_u32 s77, s68, 147456
    s_add_u32 s78, s68, 163840
    s_branch L_pg_29
.p2align 12
L_pg_29:
    s_waitcnt vmcnt(6)
    s_barrier
    s_setprio 1
    ds_read_b64_tr_b16 v[184:185], v45 offset:0
    v_mfma_f32_16x16x32_bf16 v[32:35], v[50:53], v[112:115], v[32:35]
    ds_read_b64_tr_b16 v[186:187], v45 offset:1536
    v_mfma_f32_16x16x32_bf16 v[36:39], v[50:53], v[116:119], v[36:39]
    ds_read_b64_tr_b16 v[188:189], v45 offset:128
    v_mfma_f32_16x16x32_bf16 v[40:43], v[50:53], v[120:123], v[40:43]
    ds_read_b64_tr_b16 v[190:191], v45 offset:1664
    ds_read_b64_tr_b16 v[192:193], v45 offset:256
    v_mfma_f32_16x16x32_bf16 v[32:35], v[50:53], v[124:127], v[32:35]
    ds_read_b64_tr_b16 v[194:195], v45 offset:1792
    v_mfma_f32_16x16x32_bf16 v[36:39], v[50:53], v[128:131], v[36:39]
    ds_read_b64_tr_b16 v[196:197], v45 offset:12288
    v_mfma_f32_16x16x32_bf16 v[40:43], v[50:53], v[132:135], v[40:43]
    ds_read_b64_tr_b16 v[198:199], v45 offset:13824
    ds_read_b64_tr_b16 v[200:201], v45 offset:12416
    v_mfma_f32_16x16x32_bf16 v[32:35], v[50:53], v[136:139], v[32:35]
    ds_read_b64_tr_b16 v[202:203], v45 offset:13952
    v_mfma_f32_16x16x32_bf16 v[36:39], v[50:53], v[140:143], v[36:39]
    ds_read_b64_tr_b16 v[204:205], v45 offset:12544
    v_mfma_f32_16x16x32_bf16 v[40:43], v[50:53], v[144:147], v[40:43]
    ds_read_b64_tr_b16 v[206:207], v45 offset:14080
    ds_read_b64_tr_b16 v[208:209], v45 offset:24576
    v_mfma_f32_16x16x32_bf16 v[32:35], v[50:53], v[148:151], v[32:35]
    ds_read_b64_tr_b16 v[210:211], v45 offset:26112
    v_mfma_f32_16x16x32_bf16 v[36:39], v[50:53], v[152:155], v[36:39]
    ds_read_b64_tr_b16 v[212:213], v45 offset:24704
    v_mfma_f32_16x16x32_bf16 v[40:43], v[50:53], v[156:159], v[40:43]
    ds_read_b64_tr_b16 v[214:215], v45 offset:26240
    ds_read_b64_tr_b16 v[216:217], v45 offset:24832
    v_mfma_f32_16x16x32_bf16 v[32:35], v[50:53], v[160:163], v[32:35]
    ds_read_b64_tr_b16 v[218:219], v45 offset:26368
    v_mfma_f32_16x16x32_bf16 v[36:39], v[50:53], v[164:167], v[36:39]
    ds_read_b64_tr_b16 v[220:221], v45 offset:36864
    v_mfma_f32_16x16x32_bf16 v[40:43], v[50:53], v[168:171], v[40:43]
    ds_read_b64_tr_b16 v[222:223], v45 offset:38400
    ds_read_b64_tr_b16 v[224:225], v45 offset:36992
    v_mfma_f32_16x16x32_bf16 v[32:35], v[50:53], v[172:175], v[32:35]
    ds_read_b64_tr_b16 v[226:227], v45 offset:38528
    v_mfma_f32_16x16x32_bf16 v[36:39], v[50:53], v[176:179], v[36:39]
    ds_read_b64_tr_b16 v[228:229], v45 offset:37120
    v_mfma_f32_16x16x32_bf16 v[40:43], v[50:53], v[180:183], v[40:43]
    ds_read_b64_tr_b16 v[230:231], v45 offset:38656
    s_waitcnt vmcnt(0) lgkmcnt(0)
    s_barrier
    ds_read_b64_tr_b16 v[232:233], v45 offset:49152
    v_mfma_f32_16x16x32_bf16 v[32:35], v[50:53], v[184:187], v[32:35]
    ds_read_b64_tr_b16 v[234:235], v45 offset:50688
    v_mfma_f32_16x16x32_bf16 v[36:39], v[50:53], v[188:191], v[36:39]
    ds_read_b64_tr_b16 v[236:237], v45 offset:49280
    v_mfma_f32_16x16x32_bf16 v[40:43], v[50:53], v[192:195], v[40:43]
    ds_read_b64_tr_b16 v[238:239], v45 offset:50816
    v_mfma_f32_16x16x32_bf16 v[32:35], v[50:53], v[196:199], v[32:35]
    ds_read_b64_tr_b16 v[240:241], v45 offset:49408
    v_mfma_f32_16x16x32_bf16 v[36:39], v[50:53], v[200:203], v[36:39]
    ds_read_b64_tr_b16 v[242:243], v45 offset:50944
    v_mfma_f32_16x16x32_bf16 v[40:43], v[50:53], v[204:207], v[40:43]
    ds_read_b64_tr_b16 v[244:245], v45 offset:61440
    v_mfma_f32_16x16x32_bf16 v[32:35], v[50:53], v[208:211], v[32:35]
    ds_read_b64_tr_b16 v[246:247], v45 offset:62976
    v_mfma_f32_16x16x32_bf16 v[36:39], v[50:53], v[212:215], v[36:39]
    ds_read_b64_tr_b16 v[248:249], v45 offset:61568
    v_mfma_f32_16x16x32_bf16 v[40:43], v[50:53], v[216:219], v[40:43]
    ds_read_b64_tr_b16 v[250:251], v45 offset:63104
    v_mfma_f32_16x16x32_bf16 v[32:35], v[50:53], v[220:223], v[32:35]
    ds_read_b64_tr_b16 v[252:253], v45 offset:61696
    v_mfma_f32_16x16x32_bf16 v[36:39], v[50:53], v[224:227], v[36:39]
    ds_read_b64_tr_b16 v[254:255], v45 offset:63232
    v_mfma_f32_16x16x32_bf16 v[40:43], v[50:53], v[228:231], v[40:43]
    s_waitcnt lgkmcnt(0)
    v_mfma_f32_16x16x32_bf16 v[32:35], v[50:53], v[232:235], v[32:35]
    v_mfma_f32_16x16x32_bf16 v[36:39], v[50:53], v[236:239], v[36:39]
    v_mfma_f32_16x16x32_bf16 v[40:43], v[50:53], v[240:243], v[40:43]
    v_mfma_f32_16x16x32_bf16 v[32:35], v[50:53], v[244:247], v[32:35]
    v_mfma_f32_16x16x32_bf16 v[36:39], v[50:53], v[248:251], v[36:39]
    v_mfma_f32_16x16x32_bf16 v[40:43], v[50:53], v[252:255], v[40:43]
    s_barrier
    s_setprio 3
    ds_read_b128 v[6:9], v1 offset:0
    ds_read_b128 v[10:13], v1 offset:1024
    ds_read_b128 v[60:63], v1 offset:2048
    s_waitcnt lgkmcnt(2)
    v_mfma_f32_16x16x32_bf16 v[44:47], v[64:67], v[6:9], 0
    v_mfma_f32_16x16x32_bf16 v[48:51], v[68:71], v[6:9], 0
    v_mfma_f32_16x16x32_bf16 v[52:55], v[72:75], v[6:9], 0
    ds_read_b128 v[6:9], v1 offset:3072
    s_waitcnt lgkmcnt(2)
    v_mfma_f32_16x16x32_bf16 v[44:47], v[76:79], v[10:13], v[44:47]
    v_mfma_f32_16x16x32_bf16 v[48:51], v[80:83], v[10:13], v[48:51]
    v_mfma_f32_16x16x32_bf16 v[52:55], v[84:87], v[10:13], v[52:55]
    ds_read_b128 v[10:13], v1 offset:4096
    ds_write_b32 v14, v32 offset:0
    s_waitcnt lgkmcnt(3)
    v_mfma_f32_16x16x32_bf16 v[44:47], v[88:91], v[60:63], v[44:47]
    v_mfma_f32_16x16x32_bf16 v[48:51], v[92:95], v[60:63], v[48:51]
    v_mfma_f32_16x16x32_bf16 v[52:55], v[96:99], v[60:63], v[52:55]
    ds_read_b128 v[60:63], v1 offset:5120
    s_waitcnt lgkmcnt(3)
    v_mfma_f32_16x16x32_bf16 v[44:47], v[100:103], v[6:9], v[44:47]
    v_mfma_f32_16x16x32_bf16 v[48:51], v[104:107], v[6:9], v[48:51]
    v_mfma_f32_16x16x32_bf16 v[52:55], v[108:111], v[6:9], v[52:55]
    ds_read_b128 v[6:9], v1 offset:6144
    ds_write_b32 v14, v36 offset:64
    s_waitcnt lgkmcnt(4)
    v_mfma_f32_16x16x32_bf16 v[44:47], v[112:115], v[10:13], v[44:47]
    v_mfma_f32_16x16x32_bf16 v[48:51], v[116:119], v[10:13], v[48:51]
    v_mfma_f32_16x16x32_bf16 v[52:55], v[120:123], v[10:13], v[52:55]
    ds_read_b128 v[10:13], v1 offset:7168
    s_waitcnt lgkmcnt(3)
    v_mfma_f32_16x16x32_bf16 v[44:47], v[124:127], v[60:63], v[44:47]
    v_mfma_f32_16x16x32_bf16 v[48:51], v[128:131], v[60:63], v[48:51]
    v_mfma_f32_16x16x32_bf16 v[52:55], v[132:135], v[60:63], v[52:55]
    ds_read_b128 v[60:63], v1 offset:8192
    ds_write_b32 v14, v40 offset:128
    s_waitcnt lgkmcnt(4)
    v_mfma_f32_16x16x32_bf16 v[44:47], v[136:139], v[6:9], v[44:47]
    v_mfma_f32_16x16x32_bf16 v[48:51], v[140:143], v[6:9], v[48:51]
    v_mfma_f32_16x16x32_bf16 v[52:55], v[144:147], v[6:9], v[52:55]
    ds_read_b128 v[6:9], v1 offset:9216
    s_waitcnt lgkmcnt(3)
    v_mfma_f32_16x16x32_bf16 v[44:47], v[148:151], v[10:13], v[44:47]
    v_mfma_f32_16x16x32_bf16 v[48:51], v[152:155], v[10:13], v[48:51]
    v_mfma_f32_16x16x32_bf16 v[52:55], v[156:159], v[10:13], v[52:55]
    ds_read_b128 v[10:13], v1 offset:10240
    s_waitcnt lgkmcnt(3)
    v_mfma_f32_16x16x32_bf16 v[44:47], v[160:163], v[60:63], v[44:47]
    v_mfma_f32_16x16x32_bf16 v[48:51], v[164:167], v[60:63], v[48:51]
    v_mfma_f32_16x16x32_bf16 v[52:55], v[168:171], v[60:63], v[52:55]
    ds_read_b128 v[60:63], v1 offset:11264
    ds_read_b128 v[32:35], v2 offset:0
    s_waitcnt lgkmcnt(3)
    v_mfma_f32_16x16x32_bf16 v[44:47], v[172:175], v[6:9], v[44:47]
    v_mfma_f32_16x16x32_bf16 v[48:51], v[176:179], v[6:9], v[48:51]
    v_mfma_f32_16x16x32_bf16 v[52:55], v[180:183], v[6:9], v[52:55]
    ds_read_b128 v[6:9], v1 offset:12288
    ds_read_b128 v[36:39], v2 offset:64
    s_waitcnt lgkmcnt(4)
    v_mfma_f32_16x16x32_bf16 v[44:47], v[184:187], v[10:13], v[44:47]
    v_mfma_f32_16x16x32_bf16 v[48:51], v[188:191], v[10:13], v[48:51]
    v_mfma_f32_16x16x32_bf16 v[52:55], v[192:195], v[10:13], v[52:55]
    ds_read_b128 v[10:13], v1 offset:13312
    ds_read_b128 v[40:43], v2 offset:128
    s_waitcnt lgkmcnt(5)
    v_mfma_f32_16x16x32_bf16 v[44:47], v[196:199], v[60:63], v[44:47]
    v_mfma_f32_16x16x32_bf16 v[48:51], v[200:203], v[60:63], v[48:51]
    v_mfma_f32_16x16x32_bf16 v[52:55], v[204:207], v[60:63], v[52:55]
    ds_read_b128 v[60:63], v1 offset:14336
    s_waitcnt lgkmcnt(4)
    v_mfma_f32_16x16x32_bf16 v[44:47], v[208:211], v[6:9], v[44:47]
    v_mfma_f32_16x16x32_bf16 v[48:51], v[212:215], v[6:9], v[48:51]
    v_mfma_f32_16x16x32_bf16 v[52:55], v[216:219], v[6:9], v[52:55]
    ds_read_b128 v[6:9], v1 offset:15360
    s_waitcnt lgkmcnt(3)
    v_mfma_f32_16x16x32_bf16 v[44:47], v[220:223], v[10:13], v[44:47]
    v_mfma_f32_16x16x32_bf16 v[48:51], v[224:227], v[10:13], v[48:51]
    v_mfma_f32_16x16x32_bf16 v[52:55], v[228:231], v[10:13], v[52:55]
    s_waitcnt lgkmcnt(1)
    v_mfma_f32_16x16x32_bf16 v[44:47], v[232:235], v[60:63], v[44:47]
    v_mfma_f32_16x16x32_bf16 v[48:51], v[236:239], v[60:63], v[48:51]
    v_mfma_f32_16x16x32_bf16 v[52:55], v[240:243], v[60:63], v[52:55]
    s_waitcnt lgkmcnt(0)
    v_mfma_f32_16x16x32_bf16 v[44:47], v[244:247], v[6:9], v[44:47]
    v_mfma_f32_16x16x32_bf16 v[48:51], v[248:251], v[6:9], v[48:51]
    v_mfma_f32_16x16x32_bf16 v[52:55], v[252:255], v[6:9], v[52:55]
    s_barrier
    ds_read_b128 v[56:59], v3
    ds_read_b128 v[10:13], v1 offset:16384
    ds_read_b128 v[60:63], v1 offset:17408
    ds_read_b128 v[6:9], v1 offset:18432
    s_waitcnt lgkmcnt(3)
    v_pk_fma_f32 v[32:33], v[32:33], v[56:57], v[44:45] op_sel_hi:[1,0,1]
    v_pk_fma_f32 v[34:35], v[34:35], v[56:57], v[46:47] op_sel_hi:[1,0,1]
    v_pk_fma_f32 v[36:37], v[36:37], v[56:57], v[48:49] op_sel_hi:[1,0,1]
    v_pk_fma_f32 v[38:39], v[38:39], v[56:57], v[50:51] op_sel_hi:[1,0,1]
    v_pk_fma_f32 v[40:41], v[40:41], v[56:57], v[52:53] op_sel_hi:[1,0,1]
    v_pk_fma_f32 v[42:43], v[42:43], v[56:57], v[54:55] op_sel_hi:[1,0,1]
    v_pk_mul_f32 v[16:17], v[32:33], v[32:33]
    v_pk_mul_f32 v[18:19], v[34:35], v[34:35]
    v_pk_mul_f32 v[22:23], v[36:37], v[36:37]
    v_pk_mul_f32 v[24:25], v[38:39], v[38:39]
    v_pk_mul_f32 v[28:29], v[40:41], v[40:41]
    v_pk_mul_f32 v[30:31], v[42:43], v[42:43]
    v_pk_fma_f32 v[16:17], v[16:17], v[58:59], v[56:57] op_sel:[0,0,1] op_sel_hi:[1,0,1]
    v_pk_fma_f32 v[18:19], v[18:19], v[58:59], v[56:57] op_sel:[0,0,1] op_sel_hi:[1,0,1]
    v_pk_fma_f32 v[22:23], v[22:23], v[58:59], v[56:57] op_sel:[0,0,1] op_sel_hi:[1,0,1]
    v_pk_fma_f32 v[24:25], v[24:25], v[58:59], v[56:57] op_sel:[0,0,1] op_sel_hi:[1,0,1]
    v_pk_fma_f32 v[28:29], v[28:29], v[58:59], v[56:57] op_sel:[0,0,1] op_sel_hi:[1,0,1]
    v_pk_fma_f32 v[30:31], v[30:31], v[58:59], v[56:57] op_sel:[0,0,1] op_sel_hi:[1,0,1]
    v_pk_mul_f32 v[16:17], v[16:17], v[32:33]
    v_pk_mul_f32 v[18:19], v[18:19], v[34:35]
    v_pk_mul_f32 v[22:23], v[22:23], v[36:37]
    v_pk_mul_f32 v[24:25], v[24:25], v[38:39]
    v_pk_mul_f32 v[28:29], v[28:29], v[40:41]
    v_pk_mul_f32 v[30:31], v[30:31], v[42:43]
    s_waitcnt lgkmcnt(2)
    v_mfma_f32_16x16x32_bf16 v[44:47], v[64:67], v[10:13], 0
    v_exp_f32 v16, v16
    v_mfma_f32_16x16x32_bf16 v[48:51], v[68:71], v[10:13], 0
    v_exp_f32 v17, v17
    v_mfma_f32_16x16x32_bf16 v[52:55], v[72:75], v[10:13], 0
    v_exp_f32 v18, v18
    ds_read_b128 v[10:13], v1 offset:19456
    s_waitcnt lgkmcnt(2)
    v_mfma_f32_16x16x32_bf16 v[44:47], v[76:79], v[60:63], v[44:47]
    v_exp_f32 v19, v19
    v_mfma_f32_16x16x32_bf16 v[48:51], v[80:83], v[60:63], v[48:51]
    v_fma_f32 v16, v16, v59, v59
    v_fma_f32 v17, v17, v59, v59
    v_mfma_f32_16x16x32_bf16 v[52:55], v[84:87], v[60:63], v[52:55]
    v_fma_f32 v18, v18, v59, v59
    v_fma_f32 v19, v19, v59, v59
    ds_read_b128 v[60:63], v1 offset:20480
    s_waitcnt lgkmcnt(2)
    v_mfma_f32_16x16x32_bf16 v[44:47], v[88:91], v[6:9], v[44:47]
    v_exp_f32 v22, v22
    v_mfma_f32_16x16x32_bf16 v[48:51], v[92:95], v[6:9], v[48:51]
    v_exp_f32 v23, v23
    v_mfma_f32_16x16x32_bf16 v[52:55], v[96:99], v[6:9], v[52:55]
    v_exp_f32 v24, v24
    ds_read_b128 v[6:9], v1 offset:21504
    s_waitcnt lgkmcnt(2)
    v_mfma_f32_16x16x32_bf16 v[44:47], v[100:103], v[10:13], v[44:47]
    v_exp_f32 v25, v25
    v_mfma_f32_16x16x32_bf16 v[48:51], v[104:107], v[10:13], v[48:51]
    v_fma_f32 v22, v22, v59, v59
    v_fma_f32 v23, v23, v59, v59
    v_mfma_f32_16x16x32_bf16 v[52:55], v[108:111], v[10:13], v[52:55]
    ds_read_b128 v[10:13], v1 offset:22528
    s_waitcnt lgkmcnt(2)
    v_mfma_f32_16x16x32_bf16 v[44:47], v[112:115], v[60:63], v[44:47]
    v_fma_f32 v24, v24, v59, v59
    v_fma_f32 v25, v25, v59, v59
    v_mfma_f32_16x16x32_bf16 v[48:51], v[116:119], v[60:63], v[48:51]
    v_exp_f32 v28, v28
    v_mfma_f32_16x16x32_bf16 v[52:55], v[120:123], v[60:63], v[52:55]
    ds_read_b128 v[60:63], v1 offset:23552
    s_waitcnt lgkmcnt(2)
    v_mfma_f32_16x16x32_bf16 v[44:47], v[124:127], v[6:9], v[44:47]
    v_exp_f32 v29, v29
    v_mfma_f32_16x16x32_bf16 v[48:51], v[128:131], v[6:9], v[48:51]
    v_exp_f32 v30, v30
    v_mfma_f32_16x16x32_bf16 v[52:55], v[132:135], v[6:9], v[52:55]
    ds_read_b128 v[6:9], v1 offset:24576
    s_waitcnt lgkmcnt(2)
    v_mfma_f32_16x16x32_bf16 v[44:47], v[136:139], v[10:13], v[44:47]
    v_exp_f32 v31, v31
    v_mfma_f32_16x16x32_bf16 v[48:51], v[140:143], v[10:13], v[48:51]
    v_fma_f32 v28, v28, v59, v59
    v_fma_f32 v29, v29, v59, v59
    v_mfma_f32_16x16x32_bf16 v[52:55], v[144:147], v[10:13], v[52:55]
    ds_read_b128 v[10:13], v1 offset:25600
    s_waitcnt lgkmcnt(2)
    v_mfma_f32_16x16x32_bf16 v[44:47], v[148:151], v[60:63], v[44:47]
    v_fma_f32 v30, v30, v59, v59
    v_fma_f32 v31, v31, v59, v59
    v_mfma_f32_16x16x32_bf16 v[48:51], v[152:155], v[60:63], v[48:51]
    v_rcp_f32 v16, v16
    v_mfma_f32_16x16x32_bf16 v[52:55], v[156:159], v[60:63], v[52:55]
    ds_read_b128 v[60:63], v1 offset:26624
    s_waitcnt lgkmcnt(2)
    v_mfma_f32_16x16x32_bf16 v[44:47], v[160:163], v[6:9], v[44:47]
    v_rcp_f32 v17, v17
    v_mfma_f32_16x16x32_bf16 v[48:51], v[164:167], v[6:9], v[48:51]
    v_rcp_f32 v18, v18
    v_mfma_f32_16x16x32_bf16 v[52:55], v[168:171], v[6:9], v[52:55]
    ds_read_b128 v[6:9], v1 offset:27648
    s_waitcnt lgkmcnt(2)
    v_mfma_f32_16x16x32_bf16 v[44:47], v[172:175], v[10:13], v[44:47]
    v_rcp_f32 v19, v19
    v_mfma_f32_16x16x32_bf16 v[48:51], v[176:179], v[10:13], v[48:51]
    v_mul_f32 v16, v16, v32
    v_mul_f32 v17, v17, v33
    v_mfma_f32_16x16x32_bf16 v[52:55], v[180:183], v[10:13], v[52:55]
    ds_read_b128 v[10:13], v1 offset:28672
    s_waitcnt lgkmcnt(2)
    v_mfma_f32_16x16x32_bf16 v[44:47], v[184:187], v[60:63], v[44:47]
    v_mul_f32 v18, v18, v34
    v_mul_f32 v19, v19, v35
    v_mfma_f32_16x16x32_bf16 v[48:51], v[188:191], v[60:63], v[48:51]
    v_cvt_pk_bf16_f32 v14, v16, v17
    v_cvt_pk_bf16_f32 v15, v18, v19
    v_mfma_f32_16x16x32_bf16 v[52:55], v[192:195], v[60:63], v[52:55]
    ds_read_b128 v[60:63], v1 offset:29696
    s_waitcnt lgkmcnt(2)
    v_mfma_f32_16x16x32_bf16 v[44:47], v[196:199], v[6:9], v[44:47]
    v_rcp_f32 v22, v22
    v_mfma_f32_16x16x32_bf16 v[48:51], v[200:203], v[6:9], v[48:51]
    v_rcp_f32 v23, v23
    v_mfma_f32_16x16x32_bf16 v[52:55], v[204:207], v[6:9], v[52:55]
    ds_read_b128 v[6:9], v1 offset:30720
    s_waitcnt lgkmcnt(2)
    v_mfma_f32_16x16x32_bf16 v[44:47], v[208:211], v[10:13], v[44:47]
    v_rcp_f32 v24, v24
    v_mfma_f32_16x16x32_bf16 v[48:51], v[212:215], v[10:13], v[48:51]
    v_rcp_f32 v25, v25
    v_mfma_f32_16x16x32_bf16 v[52:55], v[216:219], v[10:13], v[52:55]
    ds_read_b128 v[10:13], v1 offset:31744
    s_waitcnt lgkmcnt(2)
    v_mfma_f32_16x16x32_bf16 v[44:47], v[220:223], v[60:63], v[44:47]
    v_mul_f32 v22, v22, v36
    v_mul_f32 v23, v23, v37
    v_mfma_f32_16x16x32_bf16 v[48:51], v[224:227], v[60:63], v[48:51]
    v_mul_f32 v24, v24, v38
    v_mul_f32 v25, v25, v39
    v_mfma_f32_16x16x32_bf16 v[52:55], v[228:231], v[60:63], v[52:55]
    s_waitcnt lgkmcnt(1)
    v_mfma_f32_16x16x32_bf16 v[44:47], v[232:235], v[6:9], v[44:47]
    ds_read_b128 v[32:35], v2
    ds_read_b128 v[36:39], v2 offset:64
    v_mfma_f32_16x16x32_bf16 v[48:51], v[236:239], v[6:9], v[48:51]
    v_cvt_pk_bf16_f32 v20, v22, v23
    v_cvt_pk_bf16_f32 v21, v24, v25
    v_mfma_f32_16x16x32_bf16 v[52:55], v[240:243], v[6:9], v[52:55]
    s_waitcnt lgkmcnt(2)
    v_mfma_f32_16x16x32_bf16 v[44:47], v[244:247], v[10:13], v[44:47]
    v_rcp_f32 v28, v28
    v_mfma_f32_16x16x32_bf16 v[48:51], v[248:251], v[10:13], v[48:51]
    v_rcp_f32 v29, v29
    v_mfma_f32_16x16x32_bf16 v[52:55], v[252:255], v[10:13], v[52:55]
    v_rcp_f32 v30, v30
    v_rcp_f32 v31, v31
    v_mul_f32 v28, v28, v40
    v_mul_f32 v29, v29, v41
    v_mul_f32 v30, v30, v42
    v_mul_f32 v31, v31, v43
    ds_read_b128 v[40:43], v2 offset:128
    ds_read_b128 v[56:59], v3 offset:256
    v_cvt_pk_bf16_f32 v26, v28, v29
    v_cvt_pk_bf16_f32 v27, v30, v31
    s_barrier
    ds_read_b128 v[60:63], v1 offset:32768
    ds_read_b128 v[6:9], v1 offset:33792
    ds_read_b128 v[10:13], v1 offset:34816
    s_waitcnt lgkmcnt(3)
    v_pk_fma_f32 v[32:33], v[32:33], v[56:57], v[44:45] op_sel_hi:[1,0,1]
    v_pk_fma_f32 v[34:35], v[34:35], v[56:57], v[46:47] op_sel_hi:[1,0,1]
    v_pk_fma_f32 v[36:37], v[36:37], v[56:57], v[48:49] op_sel_hi:[1,0,1]
    v_pk_fma_f32 v[38:39], v[38:39], v[56:57], v[50:51] op_sel_hi:[1,0,1]
    v_pk_fma_f32 v[40:41], v[40:41], v[56:57], v[52:53] op_sel_hi:[1,0,1]
    v_pk_fma_f32 v[42:43], v[42:43], v[56:57], v[54:55] op_sel_hi:[1,0,1]
    v_pk_mul_f32 v[16:17], v[32:33], v[32:33]
    v_pk_mul_f32 v[18:19], v[34:35], v[34:35]
    v_pk_mul_f32 v[22:23], v[36:37], v[36:37]
    v_pk_mul_f32 v[24:25], v[38:39], v[38:39]
    v_pk_mul_f32 v[28:29], v[40:41], v[40:41]
    v_pk_mul_f32 v[30:31], v[42:43], v[42:43]
    v_pk_fma_f32 v[16:17], v[16:17], v[58:59], v[56:57] op_sel:[0,0,1] op_sel_hi:[1,0,1]
    v_pk_fma_f32 v[18:19], v[18:19], v[58:59], v[56:57] op_sel:[0,0,1] op_sel_hi:[1,0,1]
    v_pk_fma_f32 v[22:23], v[22:23], v[58:59], v[56:57] op_sel:[0,0,1] op_sel_hi:[1,0,1]
    v_pk_fma_f32 v[24:25], v[24:25], v[58:59], v[56:57] op_sel:[0,0,1] op_sel_hi:[1,0,1]
    v_pk_fma_f32 v[28:29], v[28:29], v[58:59], v[56:57] op_sel:[0,0,1] op_sel_hi:[1,0,1]
    v_pk_fma_f32 v[30:31], v[30:31], v[58:59], v[56:57] op_sel:[0,0,1] op_sel_hi:[1,0,1]
    v_pk_mul_f32 v[16:17], v[16:17], v[32:33]
    v_pk_mul_f32 v[18:19], v[18:19], v[34:35]
    v_pk_mul_f32 v[22:23], v[22:23], v[36:37]
    v_pk_mul_f32 v[24:25], v[24:25], v[38:39]
    v_pk_mul_f32 v[28:29], v[28:29], v[40:41]
    v_pk_mul_f32 v[30:31], v[30:31], v[42:43]
    s_waitcnt lgkmcnt(2)
    v_mfma_f32_16x16x32_bf16 v[44:47], v[64:67], v[60:63], 0
    v_exp_f32 v16, v16
    v_mfma_f32_16x16x32_bf16 v[48:51], v[68:71], v[60:63], 0
    v_exp_f32 v17, v17
    v_mfma_f32_16x16x32_bf16 v[52:55], v[72:75], v[60:63], 0
    v_exp_f32 v18, v18
    ds_read_b128 v[60:63], v1 offset:35840
    s_waitcnt lgkmcnt(2)
    v_mfma_f32_16x16x32_bf16 v[44:47], v[76:79], v[6:9], v[44:47]
    v_exp_f32 v19, v19
    v_mfma_f32_16x16x32_bf16 v[48:51], v[80:83], v[6:9], v[48:51]
    v_fma_f32 v16, v16, v59, v59
    v_fma_f32 v17, v17, v59, v59
    v_mfma_f32_16x16x32_bf16 v[52:55], v[84:87], v[6:9], v[52:55]
    v_fma_f32 v18, v18, v59, v59
    v_fma_f32 v19, v19, v59, v59
    ds_read_b128 v[6:9], v1 offset:36864
    s_waitcnt lgkmcnt(2)
    v_mfma_f32_16x16x32_bf16 v[44:47], v[88:91], v[10:13], v[44:47]
    v_exp_f32 v22, v22
    v_mfma_f32_16x16x32_bf16 v[48:51], v[92:95], v[10:13], v[48:51]
    v_exp_f32 v23, v23
    v_mfma_f32_16x16x32_bf16 v[52:55], v[96:99], v[10:13], v[52:55]
    v_exp_f32 v24, v24
    ds_read_b128 v[10:13], v1 offset:37888
    s_waitcnt lgkmcnt(2)
    v_mfma_f32_16x16x32_bf16 v[44:47], v[100:103], v[60:63], v[44:47]
    v_exp_f32 v25, v25
    v_mfma_f32_16x16x32_bf16 v[48:51], v[104:107], v[60:63], v[48:51]
    v_fma_f32 v22, v22, v59, v59
    v_fma_f32 v23, v23, v59, v59
    v_mfma_f32_16x16x32_bf16 v[52:55], v[108:111], v[60:63], v[52:55]
    v_fma_f32 v24, v24, v59, v59
    v_fma_f32 v25, v25, v59, v59
    ds_read_b128 v[60:63], v1 offset:38912
    s_waitcnt lgkmcnt(2)
    v_mfma_f32_16x16x32_bf16 v[44:47], v[112:115], v[6:9], v[44:47]
    v_exp_f32 v28, v28
    v_mfma_f32_16x16x32_bf16 v[48:51], v[116:119], v[6:9], v[48:51]
    v_exp_f32 v29, v29
    v_mfma_f32_16x16x32_bf16 v[52:55], v[120:123], v[6:9], v[52:55]
    v_exp_f32 v30, v30
    ds_read_b128 v[6:9], v1 offset:39936
    s_waitcnt lgkmcnt(2)
    v_mfma_f32_16x16x32_bf16 v[44:47], v[124:127], v[10:13], v[44:47]
    v_exp_f32 v31, v31
    v_mfma_f32_16x16x32_bf16 v[48:51], v[128:131], v[10:13], v[48:51]
    v_fma_f32 v28, v28, v59, v59
    v_fma_f32 v29, v29, v59, v59
    v_mfma_f32_16x16x32_bf16 v[52:55], v[132:135], v[10:13], v[52:55]
    v_fma_f32 v30, v30, v59, v59
    v_fma_f32 v31, v31, v59, v59
    ds_read_b128 v[10:13], v1 offset:40960
    s_waitcnt lgkmcnt(2)
    v_mfma_f32_16x16x32_bf16 v[44:47], v[136:139], v[60:63], v[44:47]
    v_rcp_f32 v16, v16
    v_mfma_f32_16x16x32_bf16 v[48:51], v[140:143], v[60:63], v[48:51]
    v_rcp_f32 v17, v17
    v_mfma_f32_16x16x32_bf16 v[52:55], v[144:147], v[60:63], v[52:55]
    v_rcp_f32 v18, v18
    ds_read_b128 v[60:63], v1 offset:41984
    s_waitcnt lgkmcnt(2)
    v_mfma_f32_16x16x32_bf16 v[44:47], v[148:151], v[6:9], v[44:47]
    v_rcp_f32 v19, v19
    v_mfma_f32_16x16x32_bf16 v[48:51], v[152:155], v[6:9], v[48:51]
    v_mul_f32 v16, v16, v32
    v_mul_f32 v17, v17, v33
    v_mfma_f32_16x16x32_bf16 v[52:55], v[156:159], v[6:9], v[52:55]
    v_mul_f32 v18, v18, v34
    v_mul_f32 v19, v19, v35
    ds_read_b128 v[6:9], v1 offset:43008
    s_barrier
    s_waitcnt lgkmcnt(2)
    v_mfma_f32_16x16x32_bf16 v[44:47], v[160:163], v[10:13], v[44:47]
    v_cvt_pk_bf16_f32 v16, v16, v17
    v_cvt_pk_bf16_f32 v17, v18, v19
    v_mfma_f32_16x16x32_bf16 v[48:51], v[164:167], v[10:13], v[48:51]
    v_rcp_f32 v22, v22
    v_mfma_f32_16x16x32_bf16 v[52:55], v[168:171], v[10:13], v[52:55]
    v_rcp_f32 v23, v23
    ds_read_b128 v[10:13], v1 offset:44032
    s_waitcnt lgkmcnt(2)
    v_mfma_f32_16x16x32_bf16 v[44:47], v[172:175], v[60:63], v[44:47]
    v_rcp_f32 v24, v24
    v_mfma_f32_16x16x32_bf16 v[48:51], v[176:179], v[60:63], v[48:51]
    v_rcp_f32 v25, v25
    v_mfma_f32_16x16x32_bf16 v[52:55], v[180:183], v[60:63], v[52:55]
    v_mul_f32 v22, v22, v36
    v_mul_f32 v23, v23, v37
    ds_read_b128 v[60:63], v1 offset:45056
    s_waitcnt lgkmcnt(2)
    v_mfma_f32_16x16x32_bf16 v[44:47], v[184:187], v[6:9], v[44:47]
    v_mul_f32 v24, v24, v38
    v_mul_f32 v25, v25, v39
    v_mfma_f32_16x16x32_bf16 v[48:51], v[188:191], v[6:9], v[48:51]
    ds_read_b128 v[32:35], v2
    ds_read_b128 v[36:39], v2 offset:64
    v_mfma_f32_16x16x32_bf16 v[52:55], v[192:195], v[6:9], v[52:55]
    v_cvt_pk_bf16_f32 v22, v22, v23
    v_cvt_pk_bf16_f32 v23, v24, v25
    ds_read_b128 v[6:9], v1 offset:46080
    s_waitcnt lgkmcnt(4)
    v_mfma_f32_16x16x32_bf16 v[44:47], v[196:199], v[10:13], v[44:47]
    v_rcp_f32 v28, v28
    v_mfma_f32_16x16x32_bf16 v[48:51], v[200:203], v[10:13], v[48:51]
    v_rcp_f32 v29, v29
    v_mfma_f32_16x16x32_bf16 v[52:55], v[204:207], v[10:13], v[52:55]
    ds_read_b128 v[10:13], v1 offset:47104
    s_waitcnt lgkmcnt(4)
    v_mfma_f32_16x16x32_bf16 v[44:47], v[208:211], v[60:63], v[44:47]
    v_rcp_f32 v30, v30
    v_mfma_f32_16x16x32_bf16 v[48:51], v[212:215], v[60:63], v[48:51]
    v_rcp_f32 v31, v31
    v_mfma_f32_16x16x32_bf16 v[52:55], v[216:219], v[60:63], v[52:55]
    ds_read_b128 v[60:63], v1 offset:48128
    s_waitcnt lgkmcnt(2)
    v_mfma_f32_16x16x32_bf16 v[44:47], v[220:223], v[6:9], v[44:47]
    v_mul_f32 v28, v28, v40
    v_mul_f32 v29, v29, v41
    v_mfma_f32_16x16x32_bf16 v[48:51], v[224:227], v[6:9], v[48:51]
    v_mul_f32 v30, v30, v42
    v_mul_f32 v31, v31, v43
    v_mfma_f32_16x16x32_bf16 v[52:55], v[228:231], v[6:9], v[52:55]
    s_waitcnt lgkmcnt(1)
    v_mfma_f32_16x16x32_bf16 v[44:47], v[232:235], v[10:13], v[44:47]
    ds_read_b128 v[40:43], v2 offset:128
    ds_read_b128 v[56:59], v3 offset:512
    v_mfma_f32_16x16x32_bf16 v[48:51], v[236:239], v[10:13], v[48:51]
    v_cvt_pk_bf16_f32 v28, v28, v29
    v_cvt_pk_bf16_f32 v29, v30, v31
    v_mfma_f32_16x16x32_bf16 v[52:55], v[240:243], v[10:13], v[52:55]
    s_waitcnt lgkmcnt(2)
    v_mfma_f32_16x16x32_bf16 v[44:47], v[244:247], v[60:63], v[44:47]
    v_permlane16_swap_b32 v14, v16
    v_mfma_f32_16x16x32_bf16 v[48:51], v[248:251], v[60:63], v[48:51]
    v_permlane16_swap_b32 v15, v17
    v_mfma_f32_16x16x32_bf16 v[52:55], v[252:255], v[60:63], v[52:55]
    v_permlane16_swap_b32 v20, v22
    v_permlane16_swap_b32 v21, v23
    v_permlane16_swap_b32 v26, v28
    v_permlane16_swap_b32 v27, v29
    s_cmp_eq_u32 s57, 0
    s_cbranch_scc1 L_st_30s
    buffer_store_dwordx4 v[14:17], v4, s[40:43], s80 offen offset:0
    buffer_store_dwordx4 v[20:23], v4, s[40:43], s81 offen offset:0
    buffer_store_dwordx4 v[26:29], v4, s[40:43], s82 offen offset:0
L_st_30e:
    s_barrier
    ds_read_b128 v[6:9], v1 offset:49152
    ds_read_b128 v[10:13], v1 offset:50176
    ds_read_b128 v[60:63], v1 offset:51200
    s_waitcnt lgkmcnt(3)
    v_pk_fma_f32 v[32:33], v[32:33], v[56:57], v[44:45] op_sel_hi:[1,0,1]
    v_pk_fma_f32 v[34:35], v[34:35], v[56:57], v[46:47] op_sel_hi:[1,0,1]
    v_pk_fma_f32 v[36:37], v[36:37], v[56:57], v[48:49] op_sel_hi:[1,0,1]
    v_pk_fma_f32 v[38:39], v[38:39], v[56:57], v[50:51] op_sel_hi:[1,0,1]
    v_pk_fma_f32 v[40:41], v[40:41], v[56:57], v[52:53] op_sel_hi:[1,0,1]
    v_pk_fma_f32 v[42:43], v[42:43], v[56:57], v[54:55] op_sel_hi:[1,0,1]
    v_pk_mul_f32 v[16:17], v[32:33], v[32:33]
    v_pk_mul_f32 v[18:19], v[34:35], v[34:35]
    v_pk_mul_f32 v[22:23], v[36:37], v[36:37]
    v_pk_mul_f32 v[24:25], v[38:39], v[38:39]
    v_pk_mul_f32 v[28:29], v[40:41], v[40:41]
    v_pk_mul_f32 v[30:31], v[42:43], v[42:43]
    v_pk_fma_f32 v[16:17], v[16:17], v[58:59], v[56:57] op_sel:[0,0,1] op_sel_hi:[1,0,1]
    v_pk_fma_f32 v[18:19], v[18:19], v[58:59], v[56:57] op_sel:[0,0,1] op_sel_hi:[1,0,1]
    v_pk_fma_f32 v[22:23], v[22:23], v[58:59], v[56:57] op_sel:[0,0,1] op_sel_hi:[1,0,1]
    v_pk_fma_f32 v[24:25], v[24:25], v[58:59], v[56:57] op_sel:[0,0,1] op_sel_hi:[1,0,1]
    v_pk_fma_f32 v[28:29], v[28:29], v[58:59], v[56:57] op_sel:[0,0,1] op_sel_hi:[1,0,1]
    v_pk_fma_f32 v[30:31], v[30:31], v[58:59], v[56:57] op_sel:[0,0,1] op_sel_hi:[1,0,1]
    v_pk_mul_f32 v[16:17], v[16:17], v[32:33]
    v_pk_mul_f32 v[18:19], v[18:19], v[34:35]
    v_pk_mul_f32 v[22:23], v[22:23], v[36:37]
    v_pk_mul_f32 v[24:25], v[24:25], v[38:39]
    v_pk_mul_f32 v[28:29], v[28:29], v[40:41]
    v_pk_mul_f32 v[30:31], v[30:31], v[42:43]
    s_waitcnt lgkmcnt(2)
    v_mfma_f32_16x16x32_bf16 v[44:47], v[64:67], v[6:9], 0
    v_exp_f32 v16, v16
    v_mfma_f32_16x16x32_bf16 v[48:51], v[68:71], v[6:9], 0
    v_exp_f32 v17, v17
    v_mfma_f32_16x16x32_bf16 v[52:55], v[72:75], v[6:9], 0
    v_exp_f32 v18, v18
    ds_read_b128 v[6:9], v1 offset:52224
    s_waitcnt lgkmcnt(2)
    v_mfma_f32_16x16x32_bf16 v[44:47], v[76:79], v[10:13], v[44:47]
    v_exp_f32 v19, v19
    v_mfma_f32_16x16x32_bf16 v[48:51], v[80:83], v[10:13], v[48:51]
    v_fma_f32 v16, v16, v59, v59
    v_fma_f32 v17, v17, v59, v59
    v_mfma_f32_16x16x32_bf16 v[52:55], v[84:87], v[10:13], v[52:55]
    v_fma_f32 v18, v18, v59, v59
    v_fma_f32 v19, v19, v59, v59
    ds_read_b128 v[10:13], v1 offset:53248
    s_waitcnt lgkmcnt(2)
    v_mfma_f32_16x16x32_bf16 v[44:47], v[88:91], v[60:63], v[44:47]
    v_exp_f32 v22, v22
    v_mfma_f32_16x16x32_bf16 v[48:51], v[92:95], v[60:63], v[48:51]
    v_exp_f32 v23, v23
    v_mfma_f32_16x16x32_bf16 v[52:55], v[96:99], v[60:63], v[52:55]
    v_exp_f32 v24, v24
    ds_read_b128 v[60:63], v1 offset:54272
    s_waitcnt lgkmcnt(2)
    v_mfma_f32_16x16x32_bf16 v[44:47], v[100:103], v[6:9], v[44:47]
    v_exp_f32 v25, v25
    v_mfma_f32_16x16x32_bf16 v[48:51], v[104:107], v[6:9], v[48:51]
    v_fma_f32 v22, v22, v59, v59
    v_fma_f32 v23, v23, v59, v59
    v_mfma_f32_16x16x32_bf16 v[52:55], v[108:111], v[6:9], v[52:55]
    ds_read_b128 v[6:9], v1 offset:55296
    s_waitcnt lgkmcnt(2)
    v_mfma_f32_16x16x32_bf16 v[44:47], v[112:115], v[10:13], v[44:47]
    v_fma_f32 v24, v24, v59, v59
    v_fma_f32 v25, v25, v59, v59
    v_mfma_f32_16x16x32_bf16 v[48:51], v[116:119], v[10:13], v[48:51]
    v_exp_f32 v28, v28
    v_mfma_f32_16x16x32_bf16 v[52:55], v[120:123], v[10:13], v[52:55]
    ds_read_b128 v[10:13], v1 offset:56320
    s_waitcnt lgkmcnt(2)
    v_mfma_f32_16x16x32_bf16 v[44:47], v[124:127], v[60:63], v[44:47]
    v_exp_f32 v29, v29
    v_mfma_f32_16x16x32_bf16 v[48:51], v[128:131], v[60:63], v[48:51]
    v_exp_f32 v30, v30
    v_mfma_f32_16x16x32_bf16 v[52:55], v[132:135], v[60:63], v[52:55]
    ds_read_b128 v[60:63], v1 offset:57344
    s_waitcnt lgkmcnt(2)
    v_mfma_f32_16x16x32_bf16 v[44:47], v[136:139], v[6:9], v[44:47]
    v_exp_f32 v31, v31
    v_mfma_f32_16x16x32_bf16 v[48:51], v[140:143], v[6:9], v[48:51]
    v_fma_f32 v28, v28, v59, v59
    v_fma_f32 v29, v29, v59, v59
    v_mfma_f32_16x16x32_bf16 v[52:55], v[144:147], v[6:9], v[52:55]
    ds_read_b128 v[6:9], v1 offset:58368
    s_waitcnt lgkmcnt(2)
    v_mfma_f32_16x16x32_bf16 v[44:47], v[148:151], v[10:13], v[44:47]
    v_fma_f32 v30, v30, v59, v59
    v_fma_f32 v31, v31, v59, v59
    v_mfma_f32_16x16x32_bf16 v[48:51], v[152:155], v[10:13], v[48:51]
    v_rcp_f32 v16, v16
    v_mfma_f32_16x16x32_bf16 v[52:55], v[156:159], v[10:13], v[52:55]
    ds_read_b128 v[10:13], v1 offset:59392
    s_barrier
    s_waitcnt lgkmcnt(2)
    v_mfma_f32_16x16x32_bf16 v[44:47], v[160:163], v[60:63], v[44:47]
    v_rcp_f32 v17, v17
    v_mfma_f32_16x16x32_bf16 v[48:51], v[164:167], v[60:63], v[48:51]
    v_rcp_f32 v18, v18
    v_mfma_f32_16x16x32_bf16 v[52:55], v[168:171], v[60:63], v[52:55]
    ds_read_b128 v[60:63], v1 offset:60416
    s_waitcnt lgkmcnt(2)
    v_mfma_f32_16x16x32_bf16 v[44:47], v[172:175], v[6:9], v[44:47]
    v_rcp_f32 v19, v19
    v_mfma_f32_16x16x32_bf16 v[48:51], v[176:179], v[6:9], v[48:51]
    v_mul_f32 v16, v16, v32
    v_mul_f32 v17, v17, v33
    v_mfma_f32_16x16x32_bf16 v[52:55], v[180:183], v[6:9], v[52:55]
    ds_read_b128 v[6:9], v1 offset:61440
    s_waitcnt lgkmcnt(2)
    v_mfma_f32_16x16x32_bf16 v[44:47], v[184:187], v[10:13], v[44:47]
    v_mul_f32 v18, v18, v34
    v_mul_f32 v19, v19, v35
    v_mfma_f32_16x16x32_bf16 v[48:51], v[188:191], v[10:13], v[48:51]
    v_cvt_pk_bf16_f32 v14, v16, v17
    v_cvt_pk_bf16_f32 v15, v18, v19
    v_mfma_f32_16x16x32_bf16 v[52:55], v[192:195], v[10:13], v[52:55]
    ds_read_b128 v[10:13], v1 offset:62464
    s_waitcnt lgkmcnt(2)
    v_mfma_f32_16x16x32_bf16 v[44:47], v[196:199], v[60:63], v[44:47]
    v_rcp_f32 v22, v22
    v_mfma_f32_16x16x32_bf16 v[48:51], v[200:203], v[60:63], v[48:51]
    v_rcp_f32 v23, v23
    v_mfma_f32_16x16x32_bf16 v[52:55], v[204:207], v[60:63], v[52:55]
    ds_read_b128 v[60:63], v1 offset:63488
    s_waitcnt lgkmcnt(2)
    v_mfma_f32_16x16x32_bf16 v[44:47], v[208:211], v[6:9], v[44:47]
    v_rcp_f32 v24, v24
    v_mfma_f32_16x16x32_bf16 v[48:51], v[212:215], v[6:9], v[48:51]
    v_rcp_f32 v25, v25
    v_mfma_f32_16x16x32_bf16 v[52:55], v[216:219], v[6:9], v[52:55]
    ds_read_b128 v[6:9], v1 offset:64512
    s_waitcnt lgkmcnt(2)
    v_mfma_f32_16x16x32_bf16 v[44:47], v[220:223], v[10:13], v[44:47]
    v_mul_f32 v22, v22, v36
    v_mul_f32 v23, v23, v37
    v_mfma_f32_16x16x32_bf16 v[48:51], v[224:227], v[10:13], v[48:51]
    v_mul_f32 v24, v24, v38
    v_mul_f32 v25, v25, v39
    v_mfma_f32_16x16x32_bf16 v[52:55], v[228:231], v[10:13], v[52:55]
    s_waitcnt lgkmcnt(1)
    v_mfma_f32_16x16x32_bf16 v[44:47], v[232:235], v[60:63], v[44:47]
    ds_read_b128 v[32:35], v2
    ds_read_b128 v[36:39], v2 offset:64
    v_mfma_f32_16x16x32_bf16 v[48:51], v[236:239], v[60:63], v[48:51]
    v_cvt_pk_bf16_f32 v20, v22, v23
    v_cvt_pk_bf16_f32 v21, v24, v25
    v_mfma_f32_16x16x32_bf16 v[52:55], v[240:243], v[60:63], v[52:55]
    s_waitcnt lgkmcnt(2)
    v_mfma_f32_16x16x32_bf16 v[44:47], v[244:247], v[6:9], v[44:47]
    v_rcp_f32 v28, v28
    v_mfma_f32_16x16x32_bf16 v[48:51], v[248:251], v[6:9], v[48:51]
    v_rcp_f32 v29, v29
    v_mfma_f32_16x16x32_bf16 v[52:55], v[252:255], v[6:9], v[52:55]
    v_rcp_f32 v30, v30
    v_rcp_f32 v31, v31
    v_mul_f32 v28, v28, v40
    v_mul_f32 v29, v29, v41
    v_mul_f32 v30, v30, v42
    v_mul_f32 v31, v31, v43
    ds_read_b128 v[40:43], v2 offset:128
    ds_read_b128 v[56:59], v3 offset:768
    v_cvt_pk_bf16_f32 v26, v28, v29
    v_cvt_pk_bf16_f32 v27, v30, v31
    s_barrier
    s_waitcnt lgkmcnt(0)
    v_pk_fma_f32 v[32:33], v[32:33], v[56:57], v[44:45] op_sel_hi:[1,0,1]
    v_pk_fma_f32 v[34:35], v[34:35], v[56:57], v[46:47] op_sel_hi:[1,0,1]
    v_pk_fma_f32 v[36:37], v[36:37], v[56:57], v[48:49] op_sel_hi:[1,0,1]
    v_pk_fma_f32 v[38:39], v[38:39], v[56:57], v[50:51] op_sel_hi:[1,0,1]
    v_pk_fma_f32 v[40:41], v[40:41], v[56:57], v[52:53] op_sel_hi:[1,0,1]
    v_pk_fma_f32 v[42:43], v[42:43], v[56:57], v[54:55] op_sel_hi:[1,0,1]
    v_pk_mul_f32 v[16:17], v[32:33], v[32:33]
    v_pk_mul_f32 v[18:19], v[34:35], v[34:35]
    v_pk_mul_f32 v[22:23], v[36:37], v[36:37]
    v_pk_mul_f32 v[24:25], v[38:39], v[38:39]
    v_pk_mul_f32 v[28:29], v[40:41], v[40:41]
    v_pk_mul_f32 v[30:31], v[42:43], v[42:43]
    v_pk_fma_f32 v[16:17], v[16:17], v[58:59], v[56:57] op_sel:[0,0,1] op_sel_hi:[1,0,1]
    v_pk_fma_f32 v[18:19], v[18:19], v[58:59], v[56:57] op_sel:[0,0,1] op_sel_hi:[1,0,1]
    v_pk_fma_f32 v[22:23], v[22:23], v[58:59], v[56:57] op_sel:[0,0,1] op_sel_hi:[1,0,1]
    v_pk_fma_f32 v[24:25], v[24:25], v[58:59], v[56:57] op_sel:[0,0,1] op_sel_hi:[1,0,1]
    v_pk_fma_f32 v[28:29], v[28:29], v[58:59], v[56:57] op_sel:[0,0,1] op_sel_hi:[1,0,1]
    v_pk_fma_f32 v[30:31], v[30:31], v[58:59], v[56:57] op_sel:[0,0,1] op_sel_hi:[1,0,1]
    v_pk_mul_f32 v[16:17], v[16:17], v[32:33]
    v_pk_mul_f32 v[18:19], v[18:19], v[34:35]
    v_pk_mul_f32 v[22:23], v[22:23], v[36:37]
    v_pk_mul_f32 v[24:25], v[24:25], v[38:39]
    v_pk_mul_f32 v[28:29], v[28:29], v[40:41]
    v_pk_mul_f32 v[30:31], v[30:31], v[42:43]
    v_exp_f32 v16, v16
    v_exp_f32 v17, v17
    v_exp_f32 v18, v18
    v_exp_f32 v19, v19
    v_exp_f32 v22, v22
    v_exp_f32 v23, v23
    v_exp_f32 v24, v24
    v_exp_f32 v25, v25
    v_exp_f32 v28, v28
    v_exp_f32 v29, v29
    v_exp_f32 v30, v30
    v_exp_f32 v31, v31
    v_pk_fma_f32 v[16:17], v[16:17], v[58:59], v[58:59] op_sel:[0,1,1] op_sel_hi:[1,1,1]
    v_pk_fma_f32 v[18:19], v[18:19], v[58:59], v[58:59] op_sel:[0,1,1] op_sel_hi:[1,1,1]
    v_pk_fma_f32 v[22:23], v[22:23], v[58:59], v[58:59] op_sel:[0,1,1] op_sel_hi:[1,1,1]
    v_pk_fma_f32 v[24:25], v[24:25], v[58:59], v[58:59] op_sel:[0,1,1] op_sel_hi:[1,1,1]
    v_pk_fma_f32 v[28:29], v[28:29], v[58:59], v[58:59] op_sel:[0,1,1] op_sel_hi:[1,1,1]
    v_pk_fma_f32 v[30:31], v[30:31], v[58:59], v[58:59] op_sel:[0,1,1] op_sel_hi:[1,1,1]
    v_rcp_f32 v16, v16
    v_rcp_f32 v17, v17
    v_rcp_f32 v18, v18
    v_rcp_f32 v19, v19
    v_pk_mul_f32 v[16:17], v[16:17], v[32:33]
    v_pk_mul_f32 v[18:19], v[18:19], v[34:35]
    v_cvt_pk_bf16_f32 v16, v16, v17
    v_cvt_pk_bf16_f32 v17, v18, v19
    v_rcp_f32 v22, v22
    v_rcp_f32 v23, v23
    v_rcp_f32 v24, v24
    v_rcp_f32 v25, v25
    v_pk_mul_f32 v[22:23], v[22:23], v[36:37]
    v_pk_mul_f32 v[24:25], v[24:25], v[38:39]
    v_cvt_pk_bf16_f32 v22, v22, v23
    v_cvt_pk_bf16_f32 v23, v24, v25
    v_rcp_f32 v28, v28
    v_rcp_f32 v29, v29
    v_rcp_f32 v30, v30
    v_rcp_f32 v31, v31
    v_pk_mul_f32 v[28:29], v[28:29], v[40:41]
    v_pk_mul_f32 v[30:31], v[30:31], v[42:43]
    v_cvt_pk_bf16_f32 v28, v28, v29
    v_cvt_pk_bf16_f32 v29, v30, v31
    v_permlane16_swap_b32 v14, v16
    v_permlane16_swap_b32 v15, v17
    v_permlane16_swap_b32 v20, v22
    v_permlane16_swap_b32 v21, v23
    v_permlane16_swap_b32 v26, v28
    v_permlane16_swap_b32 v27, v29
    s_cmp_eq_u32 s57, 0
    s_cbranch_scc1 L_st_31s
    buffer_store_dwordx4 v[14:17], v4, s[40:43], s80 offen offset:512
    buffer_store_dwordx4 v[20:23], v4, s[40:43], s81 offen offset:512
    buffer_store_dwordx4 v[26:29], v4, s[40:43], s82 offen offset:512
L_st_31e:
    s_lshl_b32 s64, s53, 2
    v_mov_b32 v6, s64
    s_add_u32 s92, s56, 7
    v_mov_b32 v7, s92
    v_and_b32 v9, 7, v0
    v_lshlrev_b32 v9, 2, v9
    s_waitcnt vmcnt(0) lgkmcnt(0)
    s_barrier
    s_setprio 2
    s_cmp_lg_u32 s52, 0
    s_cbranch_scc1 L_pub_32n
    s_cmp_eq_u32 s57, 0
    s_cbranch_scc1 L_st_33s
    buffer_store_dword v7, v6, s[40:43], s93 offen
L_st_33e:
L_pub_32n:
    s_cmp_lg_u32 s52, 0
    s_cbranch_scc1 L_pol_34
    buffer_load_dword v8, v9, s[40:43], s93 offen sc1
    s_waitcnt vmcnt(0)
L_pl_35c:
    v_subrev_u32 v8, s92, v8
    v_cmp_lt_u32 vcc, 7, v8
    s_cbranch_vccnz L_pl_35r
L_pl_35y:
L_pol_34:
    s_barrier
    s_add_u32 m0, s62, 0
    s_nop 0
    buffer_load_dwordx4 v1, s[40:43], s68 offen offset:0 sc1 lds
    buffer_load_dwordx4 v1, s[40:43], s68 offen offset:1024 sc1 lds
    buffer_load_dwordx4 v1, s[40:43], s68 offen offset:2048 sc1 lds
    buffer_load_dwordx4 v1, s[40:43], s68 offen offset:3072 sc1 lds
    s_add_u32 m0, s62, 16384
    s_nop 0
    buffer_load_dwordx4 v1, s[40:43], s69 offen offset:0 sc1 lds
    buffer_load_dwordx4 v1, s[40:43], s69 offen offset:1024 sc1 lds
    buffer_load_dwordx4 v1, s[40:43], s69 offen offset:2048 sc1 lds
    buffer_load_dwordx4 v1, s[40:43], s69 offen offset:3072 sc1 lds
    s_waitcnt vmcnt(4)
    s_barrier
    s_add_u32 m0, s62, 32768
    s_nop 0
    buffer_load_dwordx4 v1, s[40:43], s70 offen offset:0 sc1 lds
    buffer_load_dwordx4 v1, s[40:43], s70 offen offset:1024 sc1 lds
    buffer_load_dwordx4 v1, s[40:43], s70 offen offset:2048 sc1 lds
    buffer_load_dwordx4 v1, s[40:43], s70 offen offset:3072 sc1 lds
    s_add_u32 m0, s62, 49152
    s_nop 0
    buffer_load_dwordx4 v1, s[40:43], s71 offen offset:0 sc1 lds
    buffer_load_dwordx4 v1, s[40:43], s71 offen offset:1024 sc1 lds
    buffer_load_dwordx4 v1, s[40:43], s71 offen offset:2048 sc1 lds
    buffer_load_dwordx4 v1, s[40:43], s71 offen offset:3072 sc1 lds
    s_waitcnt vmcnt(8)
    s_barrier
    s_add_u32 m0, s62, 65536
    s_nop 0
    buffer_load_dwordx4 v1, s[40:43], s72 offen offset:0 sc1 lds
    buffer_load_dwordx4 v1, s[40:43], s72 offen offset:1024 sc1 lds
    buffer_load_dwordx4 v1, s[40:43], s72 offen offset:2048 sc1 lds
    buffer_load_dwordx4 v1, s[40:43], s72 offen offset:3072 sc1 lds
    s_waitcnt vmcnt(8)
    s_barrier
    s_add_u32 m0, s62, 81920
    s_nop 0
    buffer_load_dwordx4 v1, s[40:43], s73 offen offset:0 sc1 lds
    buffer_load_dwordx4 v1, s[40:43], s73 offen offset:1024 sc1 lds
    buffer_load_dwordx4 v1, s[40:43], s73 offen offset:2048 sc1 lds
    buffer_load_dwordx4 v1, s[40:43], s73 offen offset:3072 sc1 lds
    s_waitcnt vmcnt(8)
    s_barrier
    s_add_u32 m0, s62, 98304
    s_nop 0
    buffer_load_dwordx4 v1, s[40:43], s74 offen offset:0 sc1 lds
    buffer_load_dwordx4 v1, s[40:43], s74 offen offset:1024 sc1 lds
    buffer_load_dwordx4 v1, s[40:43], s74 offen offset:2048 sc1 lds
    buffer_load_dwordx4 v1, s[40:43], s74 offen offset:3072 sc1 lds
    s_waitcnt vmcnt(8)
    s_barrier
    s_add_u32 m0, s62, 114688
    s_nop 0
    buffer_load_dwordx4 v1, s[40:43], s75 offen offset:0 sc1 lds
    buffer_load_dwordx4 v1, s[40:43], s75 offen offset:1024 sc1 lds
    buffer_load_dwordx4 v1, s[40:43], s75 offen offset:2048 sc1 lds
    buffer_load_dwordx4 v1, s[40:43], s75 offen offset:3072 sc1 lds
    s_waitcnt vmcnt(8)
    s_barrier
    s_add_u32 m0, s62, 131072
    s_nop 0
    buffer_load_dwordx4 v1, s[40:43], s76 offen offset:0 sc1 lds
    buffer_load_dwordx4 v1, s[40:43], s76 offen offset:1024 sc1 lds
    buffer_load_dwordx4 v1, s[40:43], s76 offen offset:2048 sc1 lds
    buffer_load_dwordx4 v1, s[40:43], s76 offen offset:3072 sc1 lds
    s_waitcnt vmcnt(8)
    s_barrier
    s_add_u32 m0, s62, 0
    s_nop 0
    buffer_load_dwordx4 v1, s[40:43], s77 offen offset:0 sc1 lds
    buffer_load_dwordx4 v1, s[40:43], s77 offen offset:1024 sc1 lds
    buffer_load_dwordx4 v1, s[40:43], s77 offen offset:2048 sc1 lds
    buffer_load_dwordx4 v1, s[40:43], s77 offen offset:3072 sc1 lds
    s_waitcnt vmcnt(8)
    s_barrier
    s_add_u32 m0, s62, 16384
    s_nop 0
    buffer_load_dwordx4 v1, s[40:43], s78 offen offset:0 sc1 lds
    buffer_load_dwordx4 v1, s[40:43], s78 offen offset:1024 sc1 lds
    buffer_load_dwordx4 v1, s[40:43], s78 offen offset:2048 sc1 lds
    s_waitcnt vmcnt(7)
    s_barrier
    s_waitcnt vmcnt(3)
    s_barrier
    s_waitcnt vmcnt(0)
    s_barrier
    s_endpgm
L_pl_2r:
    s_sleep 2
    buffer_load_dwordx4 v[16:19], v10, s[40:43], s69 offen offset:0 sc1
    buffer_load_dwordx4 v[20:23], v10, s[40:43], s69 offen offset:1024 sc1
    buffer_load_dwordx4 v[24:27], v10, s[40:43], s69 offen offset:2048 sc1
    buffer_load_dwordx4 v[28:31], v10, s[40:43], s69 offen offset:3072 sc1
    s_sub_u32 s59, s59, 1
    s_waitcnt vmcnt(0)
    s_cbranch_scc0 L_pl_2c
    s_mov_b32 s59, 0
    s_branch L_pl_2y
L_st_14s:
    buffer_store_dword v11, v10, s[40:43], s93 offen sc1
    s_nop 1
    s_branch L_st_14e
L_pl_17r:
    buffer_load_dword v12, v13, s[40:43], s93 offen sc1
    s_sub_u32 s59, s59, 1
    s_waitcnt vmcnt(0)
    s_cbranch_scc0 L_pl_17c
    s_mov_b32 s59, 0
    s_branch L_pl_17y
L_st_20s:
    buffer_store_dwordx4 v[12:15], v46, s[40:43], s58 offen sc1
    s_nop 1
    s_branch L_st_20e
L_st_21s:
    buffer_store_dwordx4 v[16:19], v47, s[40:43], s58 offen sc1
    s_nop 1
    s_branch L_st_21e
L_st_23s:
    buffer_store_dword v21, v20, s[40:43], s93 offen sc1
    s_nop 1
    s_branch L_st_23e
L_pl_26r:
    buffer_load_dword v22, v23, s[40:43], s93 offen sc1
    s_sub_u32 s59, s59, 1
    s_waitcnt vmcnt(0)
    s_cbranch_scc0 L_pl_26c
    s_mov_b32 s59, 0
    s_branch L_pl_26y
L_pl_28r:
    s_sleep 2
    buffer_load_dwordx4 v[24:27], v1, s[40:43], s78 offen sc1
    s_sub_u32 s59, s59, 1
    s_waitcnt vmcnt(0)
    s_cbranch_scc0 L_pl_28c
    s_mov_b32 s59, 0
    s_branch L_pl_28y
L_st_30s:
    buffer_store_dwordx4 v[14:17], v4, s[40:43], s80 offen offset:0 sc1
    buffer_store_dwordx4 v[20:23], v4, s[40:43], s81 offen offset:0 sc1
    buffer_store_dwordx4 v[26:29], v4, s[40:43], s82 offen offset:0 sc1
    s_nop 1
    s_branch L_st_30e
L_st_31s:
    buffer_store_dwordx4 v[14:17], v4, s[40:43], s80 offen offset:512 sc1
    buffer_store_dwordx4 v[20:23], v4, s[40:43], s81 offen offset:512 sc1
    buffer_store_dwordx4 v[26:29], v4, s[40:43], s82 offen offset:512 sc1
    s_nop 1
    s_branch L_st_31e
L_st_33s:
    buffer_store_dword v7, v6, s[40:43], s93 offen sc1
    s_nop 1
    s_branch L_st_33e
L_pl_35r:
    buffer_load_dword v8, v9, s[40:43], s93 offen sc1
    s_sub_u32 s59, s59, 1
    s_waitcnt vmcnt(0)
    s_cbranch_scc0 L_pl_35c
    s_mov_b32 s59, 0
    s_branch L_pl_35y
L_pl_1003r:
    s_sleep 8
    buffer_load_dwordx4 v[144:147], v78, s[40:43], 0 offen offset:0 sc1
    buffer_load_dwordx4 v[148:151], v78, s[40:43], 0 offen offset:1024 sc1
    buffer_load_dwordx4 v[152:155], v78, s[40:43], 0 offen offset:2048 sc1
    buffer_load_dwordx4 v[156:159], v78, s[40:43], 0 offen offset:3072 sc1
    buffer_load_dwordx4 v[160:163], v78, s[40:43], 0 offen offset:128 sc1
    buffer_load_dwordx4 v[164:167], v78, s[40:43], 0 offen offset:1152 sc1
    buffer_load_dwordx4 v[168:171], v78, s[40:43], 0 offen offset:2176 sc1
    buffer_load_dwordx4 v[172:175], v78, s[40:43], 0 offen offset:3200 sc1
    s_sub_u32 s59, s59, 1
    s_waitcnt vmcnt(0)
    s_cbranch_scc0 L_pl_1003c
    s_mov_b32 s59, 0
    s_branch L_pl_1003y
L_st_1004s:
    buffer_store_dword v25, v24, s[40:43], s93 offen offset:128 sc1
    s_nop 1
    s_branch L_st_1004e
L_pl_1008r:
    s_sleep 8
    buffer_load_dwordx4 v[16:19], v74, s[40:43], s66 offen sc1
    buffer_load_dwordx4 v[20:23], v74, s[40:43], s67 offen sc1
    s_sub_u32 s59, s59, 1
    s_waitcnt vmcnt(0)
    s_cbranch_scc0 L_pl_1008c
    s_mov_b32 s59, 0
    s_branch L_pl_1008y
L_st_1011s:
    buffer_store_dwordx4 v[16:19], v6, s[40:43], s70 offen sc1
    buffer_store_dwordx4 v[20:23], v6, s[40:43], s70 offen offset:512 sc1
    s_nop 1
    s_branch L_st_1011e
L_st_1013s:
    buffer_store_dword v25, v24, s[40:43], s93 offen sc1
    s_nop 1
    s_branch L_st_1013e
L_st_1014s:
    buffer_store_dwordx4 v[16:19], v29, s[40:43], s64 offen sc1
    buffer_store_dwordx4 v[20:23], v29, s[40:43], s65 offen sc1
    s_nop 1
    s_branch L_st_1014e
L_pl_1016r:
    buffer_load_dword v26, v27, s[40:43], s93 offen sc1
    s_sub_u32 s59, s59, 1
    s_waitcnt vmcnt(0)
    s_cbranch_scc0 L_pl_1016c
    s_mov_b32 s59, 0
    s_branch L_pl_1016y
L_pl_1017r:
    buffer_load_dwordx4 v[128:131], v1, s[40:43], s72 offen sc1
    buffer_load_dwordx4 v[132:135], v1, s[40:43], s73 offen sc1
    buffer_load_dwordx4 v[136:139], v1, s[40:43], s74 offen sc1
    buffer_load_dwordx4 v[140:143], v1, s[40:43], s75 offen sc1
    s_sub_u32 s59, s59, 1
    s_waitcnt vmcnt(0)
    s_cbranch_scc0 L_pl_1017c
    s_mov_b32 s59, 0
    s_branch L_pl_1017y
L_st_1019s:
    buffer_store_dwordx4 v[16:19], v7, s[40:43], s70 offen sc1
    buffer_store_dwordx4 v[20:23], v7, s[40:43], s71 offen sc1
    s_nop 1
    s_branch L_st_1019e
L_st_1021s:
    buffer_store_dword v25, v24, s[40:43], s93 offen sc1
    s_nop 1
    s_branch L_st_1021e
L_st_1022s:
    buffer_store_dwordx4 v[16:19], v29, s[40:43], s64 offen sc1
    s_nop 1
    s_branch L_st_1022e
L_pl_1024r:
    buffer_load_dword v26, v27, s[40:43], s93 offen sc1
    s_sub_u32 s59, s59, 1
    s_waitcnt vmcnt(0)
    s_cbranch_scc0 L_pl_1024c
    s_mov_b32 s59, 0
    s_branch L_pl_1024y
L_pl_1025r:
    buffer_load_dwordx4 v[64:67], v1, s[40:43], s76 offen sc1
    buffer_load_dwordx4 v[68:71], v1, s[40:43], s77 offen sc1
    s_sub_u32 s59, s59, 1
    s_waitcnt vmcnt(0)
    s_cbranch_scc0 L_pl_1025c
    s_mov_b32 s59, 0
    s_branch L_pl_1025y
L_st_1027s:
    buffer_store_dword v25, v24, s[40:43], s93 offen sc1
    s_nop 1
    s_branch L_st_1027e
L_pl_1029r:
    buffer_load_dword v26, v27, s[40:43], s93 offen sc1
    s_sub_u32 s59, s59, 1
    s_waitcnt vmcnt(0)
    s_cbranch_scc0 L_pl_1029c
    s_mov_b32 s59, 0
    s_branch L_pl_1029y
L_teamB2:
    s_setprio 1
    v_lshlrev_b32 v1, 4, v0
    v_mov_b32 v14, 161808
    s_lshl_b32 s64, s52, 2
    v_add_u32 v13, s64, v14
    v_mov_b32 v6, 0x3f803f80
    v_mov_b32 v78, v19
    v_lshlrev_b32 v44, 6, v16
    v_add_u32 v44, 161856, v44
    s_lshl_b32 s65, s52, 4
    v_add_u32 v45, s65, v44
    v_lshlrev_b32 v46, 8, v17
    v_lshl_add_u32 v46, v16, 4, v46
    v_lshlrev_b32 v47, 10, v16
    v_lshl_add_u32 v47, v17, 4, v47
    s_lshl_b32 s64, s4, 2
    v_subrev_u32 v12, s64, v0
    v_and_b32 v12, 63, v12
    v_lshlrev_b32 v12, 4, v12
    v_add_u32 v12, 147456, v12
    v_lshrrev_b32 v7, 3, v0
    v_lshlrev_b32 v40, 10, v7
    v_and_b32 v7, 2, v7
    v_xor_b32 v7, v7, v0
    v_and_b32 v7, 7, v7
    v_lshl_add_u32 v40, v7, 4, v40
    s_lshl_b32 s64, s53, 7
    v_add_u32 v40, s64, v40
    v_xor_b32 v41, 64, v40
    v_add_u32 v42, 14336, v40
    v_add_u32 v43, 21504, v41
    v_add_u32 v41, 7168, v41
    v_lshrrev_b32 v7, 4, v0
    v_mul_u32_u24 v4, 1024, v7
    v_bfe_u32 v7, v0, 3, 2
    v_xor_b32 v7, s52, v7
    v_lshl_add_u32 v4, v7, 5, v4
    v_bfe_u32 v7, v0, 2, 2
    v_lshl_add_u32 v4, v7, 7, v4
    v_and_b32 v7, 3, v0
    v_lshl_add_u32 v4, v7, 3, v4
    v_add_u32 v3, 81920, v4
    s_waitcnt vmcnt(1)
    v_readfirstlane_b32 s56, v30
    s_nop 1
    s_mul_i32 s56, s56, 1664525
    s_add_u32 s56, s56, 1013904223
    v_dot2_f32_bf16 v16, v128, v6, 0
    v_dot2_f32_bf16 v17, v128, v128, 0
    v_dot2_f32_bf16 v18, v136, v6, 0
    v_dot2_f32_bf16 v19, v136, v136, 0
    v_dot2_f32_bf16 v16, v129, v6, v16
    v_dot2_f32_bf16 v17, v129, v129, v17
    v_dot2_f32_bf16 v18, v137, v6, v18
    v_dot2_f32_bf16 v19, v137, v137, v19
    v_dot2_f32_bf16 v16, v130, v6, v16
    v_dot2_f32_bf16 v17, v130, v130, v17
    v_dot2_f32_bf16 v18, v138, v6, v18
    v_dot2_f32_bf16 v19, v138, v138, v19
    v_dot2_f32_bf16 v16, v131, v6, v16
    v_dot2_f32_bf16 v17, v131, v131, v17
    v_dot2_f32_bf16 v18, v139, v6, v18
    v_dot2_f32_bf16 v19, v139, v139, v19
    v_dot2_f32_bf16 v16, v132, v6, v16
    v_dot2_f32_bf16 v17, v132, v132, v17
    v_dot2_f32_bf16 v18, v140, v6, v18
    v_dot2_f32_bf16 v19, v140, v140, v19
    v_dot2_f32_bf16 v16, v133, v6, v16
    v_dot2_f32_bf16 v17, v133, v133, v17
    v_dot2_f32_bf16 v18, v141, v6, v18
    v_dot2_f32_bf16 v19, v141, v141, v19
    v_dot2_f32_bf16 v16, v134, v6, v16
    v_dot2_f32_bf16 v17, v134, v134, v17
    v_dot2_f32_bf16 v18, v142, v6, v18
    v_dot2_f32_bf16 v19, v142, v142, v19
    v_dot2_f32_bf16 v16, v135, v6, v16
    v_dot2_f32_bf16 v17, v135, v135, v17
    v_dot2_f32_bf16 v18, v143, v6, v18
    v_dot2_f32_bf16 v19, v143, v143, v19
    v_add_f32_dpp v16, v16, v16 quad_perm:[1,0,3,2] row_mask:0xf bank_mask:0xf
    v_add_f32_dpp v17, v17, v17 quad_perm:[1,0,3,2] row_mask:0xf bank_mask:0xf
    v_add_f32_dpp v18, v18, v18 quad_perm:[1,0,3,2] row_mask:0xf bank_mask:0xf
    v_add_f32_dpp v19, v19, v19 quad_perm:[1,0,3,2] row_mask:0xf bank_mask:0xf
    v_add_f32_dpp v16, v16, v16 quad_perm:[2,3,0,1] row_mask:0xf bank_mask:0xf
    v_add_f32_dpp v17, v17, v17 quad_perm:[2,3,0,1] row_mask:0xf bank_mask:0xf
    v_add_f32_dpp v18, v18, v18 quad_perm:[2,3,0,1] row_mask:0xf bank_mask:0xf
    v_add_f32_dpp v19, v19, v19 quad_perm:[2,3,0,1] row_mask:0xf bank_mask:0xf
    v_add_f32_dpp v16, v16, v16 row_half_mirror row_mask:0xf bank_mask:0xf
    v_add_f32_dpp v17, v17, v17 row_half_mirror row_mask:0xf bank_mask:0xf
    v_add_f32_dpp v18, v18, v18 row_half_mirror row_mask:0xf bank_mask:0xf
    v_add_f32_dpp v19, v19, v19 row_half_mirror row_mask:0xf bank_mask:0xf
    ds_write_b128 v45, v[16:19]
    v_lshlrev_b32 v96, 16, v128
    v_and_b32 v97, 0xffff0000, v128
    v_lshlrev_b32 v98, 16, v129
    v_and_b32 v99, 0xffff0000, v129
    v_lshlrev_b32 v100, 16, v130
    v_and_b32 v101, 0xffff0000, v130
    v_lshlrev_b32 v102, 16, v131
    v_and_b32 v103, 0xffff0000, v131
    v_lshlrev_b32 v104, 16, v132
    v_and_b32 v105, 0xffff0000, v132
    v_lshlrev_b32 v106, 16, v133
    v_and_b32 v107, 0xffff0000, v133
    v_lshlrev_b32 v108, 16, v134
    v_and_b32 v109, 0xffff0000, v134
    v_lshlrev_b32 v110, 16, v135
    v_and_b32 v111, 0xffff0000, v135
    v_lshlrev_b32 v112, 16, v136
    v_and_b32 v113, 0xffff0000, v136
    v_lshlrev_b32 v114, 16, v137
    v_and_b32 v115, 0xffff0000, v137
    v_lshlrev_b32 v116, 16, v138
    v_and_b32 v117, 0xffff0000, v138
    v_lshlrev_b32 v118, 16, v139
    v_and_b32 v119, 0xffff0000, v139
    v_lshlrev_b32 v120, 16, v140
    v_and_b32 v121, 0xffff0000, v140
    v_lshlrev_b32 v122, 16, v141
    v_and_b32 v123, 0xffff0000, v141
    v_lshlrev_b32 v124, 16, v142
    v_and_b32 v125, 0xffff0000, v142
    v_lshlrev_b32 v126, 16, v143
    v_and_b32 v127, 0xffff0000, v143
    s_waitcnt lgkmcnt(0)
    v_mov_b32 v8, 1
    ds_write_b32 v13, v8
L_wf_1001:
    ds_read_b128 v[8:11], v14
    s_waitcnt lgkmcnt(0)
    v_min3_u32 v8, v8, v9, v10
    v_min_u32 v8, v8, v11
    v_cmp_gt_u32 vcc, 1, v8
    s_cbranch_vccnz L_wf_1001r
L_wf_1001y:
    ds_read_b128 v[16:19], v44 offset:0
    ds_read_b128 v[20:23], v44 offset:16
    ds_read_b128 v[24:27], v44 offset:32
    ds_read_b128 v[28:31], v44 offset:48
    s_waitcnt lgkmcnt(0)
    v_pk_add_f32 v[16:17], v[16:17], v[20:21]
    v_pk_add_f32 v[18:19], v[18:19], v[22:23]
    v_pk_add_f32 v[24:25], v[24:25], v[28:29]
    v_pk_add_f32 v[26:27], v[26:27], v[30:31]
    v_pk_add_f32 v[16:17], v[16:17], v[24:25]
    v_pk_add_f32 v[18:19], v[18:19], v[26:27]
    v_mul_f32 v16, 0x3b000000, v16
    v_mul_f32 v20, 0x3b000000, v17
    v_fma_f32 v20, -v16, v16, v20
    v_max_f32 v20, 0, v20
    v_add_f32 v20, 0x3727c5ac, v20
    v_rsq_f32 v20, v20
    s_nop 0
    v_mul_f32_e64 v21, -v16, v20
    v_pk_fma_f32 v[96:97], v[96:97], v[20:21], v[20:21] op_sel:[0,0,1] op_sel_hi:[1,0,1]
    v_pk_fma_f32 v[98:99], v[98:99], v[20:21], v[20:21] op_sel:[0,0,1] op_sel_hi:[1,0,1]
    v_pk_fma_f32 v[100:101], v[100:101], v[20:21], v[20:21] op_sel:[0,0,1] op_sel_hi:[1,0,1]
    v_pk_fma_f32 v[102:103], v[102:103], v[20:21], v[20:21] op_sel:[0,0,1] op_sel_hi:[1,0,1]
    v_pk_fma_f32 v[104:105], v[104:105], v[20:21], v[20:21] op_sel:[0,0,1] op_sel_hi:[1,0,1]
    v_pk_fma_f32 v[106:107], v[106:107], v[20:21], v[20:21] op_sel:[0,0,1] op_sel_hi:[1,0,1]
    v_pk_fma_f32 v[108:109], v[108:109], v[20:21], v[20:21] op_sel:[0,0,1] op_sel_hi:[1,0,1]
    v_pk_fma_f32 v[110:111], v[110:111], v[20:21], v[20:21] op_sel:[0,0,1] op_sel_hi:[1,0,1]
    v_mul_f32 v18, 0x3b000000, v18
    v_mul_f32 v22, 0x3b000000, v19
    v_fma_f32 v22, -v18, v18, v22
    v_max_f32 v22, 0, v22
    v_add_f32 v22, 0x3727c5ac, v22
    v_rsq_f32 v22, v22
    s_nop 0
    v_mul_f32_e64 v23, -v18, v22
    v_pk_fma_f32 v[112:113], v[112:113], v[22:23], v[22:23] op_sel:[0,0,1] op_sel_hi:[1,0,1]
    v_pk_fma_f32 v[114:115], v[114:115], v[22:23], v[22:23] op_sel:[0,0,1] op_sel_hi:[1,0,1]
    v_pk_fma_f32 v[116:117], v[116:117], v[22:23], v[22:23] op_sel:[0,0,1] op_sel_hi:[1,0,1]
    v_pk_fma_f32 v[118:119], v[118:119], v[22:23], v[22:23] op_sel:[0,0,1] op_sel_hi:[1,0,1]
    v_pk_fma_f32 v[120:121], v[120:121], v[22:23], v[22:23] op_sel:[0,0,1] op_sel_hi:[1,0,1]
    v_pk_fma_f32 v[122:123], v[122:123], v[22:23], v[22:23] op_sel:[0,0,1] op_sel_hi:[1,0,1]
    v_pk_fma_f32 v[124:125], v[124:125], v[22:23], v[22:23] op_sel:[0,0,1] op_sel_hi:[1,0,1]
    v_pk_fma_f32 v[126:127], v[126:127], v[22:23], v[22:23] op_sel:[0,0,1] op_sel_hi:[1,0,1]
    v_and_b32 v16, 15, v0
    v_lshrrev_b32 v17, 4, v0
    v_lshlrev_b32 v18, 4, v16
    v_lshl_add_u32 v5, v17, 12, v18
    s_and_b32 s64, s90, 3
    s_lshl_b32 s64, s64, 2
    s_bfe_u32 s65, s90, 0x20002
    s_or_b32 s64, s64, s65
    s_andn2_b32 s34, s90, 15
    s_or_b32 s34, s34, s64
    v_lshrrev_b32 v19, 5, v0
    v_lshlrev_b32 v19, 12, v19
    v_and_b32 v6, 31, v0
    v_lshl_add_u32 v6, v6, 4, v19
    s_lshl_b32 s64, s34, 10
    v_add_u32 v6, s64, v6
    v_lshrrev_b32 v19, 5, v0
    v_add_u32 v19, s90, v19
    v_lshlrev_b32 v19, 8, v19
    v_and_b32 v7, 15, v0
    v_lshl_add_u32 v7, v7, 4, v19
    v_bfe_u32 v19, v0, 4, 1
    v_lshl_add_u32 v7, v19, 14, v7
    s_lshl_b32 s65, s52, 8
    v_lshrrev_b32 v18, 2, v0
    v_lshlrev_b32 v18, 4, v18
    v_add_u32 v2, s65, v18
    v_mov_b32 v72, 161792
    s_lshr_b32 s65, s52, 1
    s_lshl_b32 s65, s65, 10
    s_and_b32 s66, s52, 1
    s_lshl_b32 s66, s66, 3
    s_add_u32 s65, s65, s66
    s_add_u32 s65, s65, 155648
    v_add_u32 v73, s65, v1
    s_lshl_b32 s65, s52, 10
    v_add_u32 v74, s65, v1
    v_add_u32 v75, 155648, v1
    v_lshlrev_b32 v76, 7, v16
    v_lshl_add_u32 v76, v17, 3, v76
    s_lshl_b32 s65, s52, 5
    s_add_u32 s65, s65, 147456
    v_add_u32 v76, s65, v76
    s_lshl_b32 s65, s90, 4
    s_add_u32 s65, s65, 155648
    v_lshlrev_b32 v77, 3, v17
    v_add_u32 v77, s65, v77
    s_min_u32 s70, s53, 3
    s_mul_i32 s71, s53, 5
    s_add_u32 s70, s70, s71
    s_lshl_b32 s70, s70, 6
    s_cmp_lt_u32 s53, 3
    s_cselect_b32 s71, 24, 20
    s_and_b32 s64, s52, 1
    s_lshl_b32 s64, s64, 2
    v_mov_b32 v18, 0x80000000
    v_add_u32 v16, 0, v0
    v_mul_u32_u24 v17, 171, v16
    v_lshrrev_b32 v17, 12, v17
    v_mul_u32_u24 v84, 24, v17
    v_sub_u32 v16, v16, v84
    v_mul_u32_u24 v84, 2752, v17
    v_and_b32 v17, 2, v17
    v_or_b32 v17, s64, v17
    v_xor_b32 v16, v16, v17
    v_cmp_gt_u32 vcc, s71, v16
    v_lshl_add_u32 v84, v16, 4, v84
    v_add_u32 v84, s70, v84
    v_cndmask_b32_e64 v84, v18, v84, vcc
    s_sub_u32 s70, s70, 1024
    v_add_u32 v16, 64, v0
    v_mul_u32_u24 v17, 171, v16
    v_lshrrev_b32 v17, 12, v17
    v_mul_u32_u24 v85, 24, v17
    v_sub_u32 v16, v16, v85
    v_mul_u32_u24 v85, 2752, v17
    v_and_b32 v17, 2, v17
    v_or_b32 v17, s64, v17
    v_xor_b32 v16, v16, v17
    v_cmp_gt_u32 vcc, s71, v16
    v_lshl_add_u32 v85, v16, 4, v85
    v_add_u32 v85, s70, v85
    v_cndmask_b32_e64 v85, v18, v85, vcc
    s_sub_u32 s70, s70, 1024
    v_add_u32 v16, 128, v0
    v_mul_u32_u24 v17, 171, v16
    v_lshrrev_b32 v17, 12, v17
    v_mul_u32_u24 v86, 24, v17
    v_sub_u32 v16, v16, v86
    v_mul_u32_u24 v86, 2752, v17
    v_and_b32 v17, 2, v17
    v_or_b32 v17, s64, v17
    v_xor_b32 v16, v16, v17
    v_cmp_gt_u32 vcc, s71, v16
    v_lshl_add_u32 v86, v16, 4, v86
    v_add_u32 v86, s70, v86
    v_cndmask_b32_e64 v86, v18, v86, vcc
    s_and_b32 s64, s52, 1
    s_lshl_b32 s64, s64, 10
    s_add_u32 s64, s64, 155648
    v_add_u32 v87, s64, v1
    ds_write_b128 v87, v[84:87]
    s_mov_b32 s36, s12
    s_mov_b32 s37, s13
    s_mov_b32 s38, 0x80000
    s_mov_b32 s39, 0x20000
    s_add_u32 s64, s4, s52
    s_add_u32 s64, s64, 0
    s_and_b32 s64, s64, 15
    s_lshl_b32 s76, s64, 15
    s_add_u32 s64, s7, s52
    s_add_u32 s64, s64, 0
    s_and_b32 s64, s64, 15
    s_lshl_b32 s85, s64, 15
    s_add_u32 s64, s4, s52
    s_add_u32 s64, s64, 4
    s_and_b32 s64, s64, 15
    s_lshl_b32 s77, s64, 15
    s_add_u32 s64, s7, s52
    s_add_u32 s64, s64, 4
    s_and_b32 s64, s64, 15
    s_lshl_b32 s86, s64, 15
    s_add_u32 s64, s4, s52
    s_add_u32 s64, s64, 8
    s_and_b32 s64, s64, 15
    s_lshl_b32 s78, s64, 15
    s_add_u32 s64, s7, s52
    s_add_u32 s64, s64, 8
    s_and_b32 s64, s64, 15
    s_lshl_b32 s87, s64, 15
    s_add_u32 s64, s4, s52
    s_add_u32 s64, s64, 12
    s_and_b32 s64, s64, 15
    s_lshl_b32 s79, s64, 15
    s_add_u32 s64, s7, s52
    s_add_u32 s64, s64, 12
    s_and_b32 s64, s64, 15
    s_lshl_b32 s88, s64, 15
    s_add_u32 s64, s53, 2
    s_lshr_b32 s65, s64, 1
    s_lshl_b32 s65, s65, 14
    s_and_b32 s64, s53, 1
    s_lshl_b32 s64, s64, 7
    s_add_u32 s64, s64, s62
    s_add_u32 s64, s64, s58
    s_add_u32 s69, s64, 0x10000
    s_add_u32 s68, s69, s65
    s_cmp_lt_u32 s53, 2
    s_cselect_b32 s69, s69, 0x80000000
    s_lshr_b32 s80, s4, 2
    s_add_u32 s80, s80, s52
    s_and_b32 s80, s80, 3
    s_lshl_b32 s80, s80, 12
    s_add_u32 s80, s80, s58
    s_add_u32 s80, s80, 0x10000
    s_add_u32 s81, s80, 16384
    s_add_u32 s82, s80, 32768
    s_add_u32 s83, s80, 49152
    s_add_u32 s84, s80, 65536
    s_mov_b32 s66, 4096
    s_mov_b32 s67, 8192
    v_mov_b32 v79, 161824
L_wf_1002:
    ds_read_b128 v[8:11], v72
    s_waitcnt lgkmcnt(0)
    v_min3_u32 v8, v8, v9, v10
    v_min_u32 v8, v8, v11
    v_cmp_gt_u32 vcc, 2, v8
    s_cbranch_vccnz L_wf_1002r
L_wf_1002y:
    s_setprio 3
    ds_read_b32 v79, v79
    s_waitcnt lgkmcnt(0)
    v_readfirstlane_b32 s57, v79
    buffer_load_dwordx4 v[144:147], v78, s[40:43], 0 offen offset:0 sc1
    buffer_load_dwordx4 v[148:151], v78, s[40:43], 0 offen offset:1024 sc1
    buffer_load_dwordx4 v[152:155], v78, s[40:43], 0 offen offset:2048 sc1
    buffer_load_dwordx4 v[156:159], v78, s[40:43], 0 offen offset:3072 sc1
    buffer_load_dwordx4 v[160:163], v78, s[40:43], 0 offen offset:128 sc1
    buffer_load_dwordx4 v[164:167], v78, s[40:43], 0 offen offset:1152 sc1
    buffer_load_dwordx4 v[168:171], v78, s[40:43], 0 offen offset:2176 sc1
    buffer_load_dwordx4 v[172:175], v78, s[40:43], 0 offen offset:3200 sc1
    s_lshl_b32 s14, s2, 2
    s_add_u32 s14, s14, s52
    s_mul_i32 s14, s14, 1408
    s_min_u32 s14, s14, 1407616
    s_add_u32 s14, s14, s20
    s_addc_u32 s15, s21, 0
    s_load_dword s35, s[14:15], 0
    s_load_dword s35, s[14:15], 64
    s_load_dword s35, s[14:15], 128
    s_load_dword s35, s[14:15], 192
    s_load_dword s35, s[14:15], 256
    s_load_dword s35, s[14:15], 320
    s_load_dword s35, s[14:15], 384
    s_load_dword s35, s[14:15], 448
    s_load_dword s35, s[14:15], 512
    s_load_dword s35, s[14:15], 576
    s_load_dword s35, s[14:15], 640
    s_load_dword s35, s[14:15], 704
    s_load_dword s35, s[14:15], 768
    s_load_dword s35, s[14:15], 832
    s_load_dword s35, s[14:15], 896
    s_waitcnt vmcnt(0)
L_pl_1003c:
    v_xor_b32 v176, s56, v145
    v_xor_b32 v177, s56, v147
    v_xor_b32 v178, s56, v149
    v_xor_b32 v179, s56, v151
    v_xor_b32 v180, s56, v153
    v_xor_b32 v181, s56, v155
    v_xor_b32 v182, s56, v157
    v_xor_b32 v183, s56, v159
    v_xor_b32 v184, s56, v161
    v_xor_b32 v185, s56, v163
    v_xor_b32 v186, s56, v165
    v_xor_b32 v187, s56, v167
    v_xor_b32 v188, s56, v169
    v_xor_b32 v189, s56, v171
    v_xor_b32 v190, s56, v173
    v_xor_b32 v191, s56, v175
    v_or3_b32 v176, v176, v177, v178
    v_or3_b32 v177, v179, v180, v181
    v_or3_b32 v178, v182, v183, v184
    v_or3_b32 v179, v185, v186, v187
    v_or3_b32 v180, v188, v189, v190
    v_or3_b32 v176, v176, v177, v178
    v_or3_b32 v179, v179, v180, v191
    v_or_b32 v176, v176, v179
    v_cmp_ne_u32 vcc, 0, v176
    s_cbranch_vccnz L_pl_1003r
L_pl_1003y:
    v_lshlrev_b32 v16, 16, v144
    v_and_b32 v17, 0xffff0000, v144
    v_lshlrev_b32 v18, 16, v146
    v_and_b32 v19, 0xffff0000, v146
    v_lshlrev_b32 v20, 16, v148
    v_and_b32 v21, 0xffff0000, v148
    v_lshlrev_b32 v22, 16, v150
    v_and_b32 v23, 0xffff0000, v150
    v_lshlrev_b32 v24, 16, v152
    v_and_b32 v25, 0xffff0000, v152
    v_lshlrev_b32 v26, 16, v154
    v_and_b32 v27, 0xffff0000, v154
    v_lshlrev_b32 v28, 16, v156
    v_and_b32 v29, 0xffff0000, v156
    v_lshlrev_b32 v30, 16, v158
    v_and_b32 v31, 0xffff0000, v158
    v_pk_fma_f32 v[96:97], v[96:97], v[24:25], v[16:17]
    v_pk_fma_f32 v[98:99], v[98:99], v[26:27], v[18:19]
    v_pk_fma_f32 v[100:101], v[100:101], v[28:29], v[20:21]
    v_pk_fma_f32 v[102:103], v[102:103], v[30:31], v[22:23]
    v_cvt_pk_bf16_f32 v96, v96, v97
    v_cvt_pk_bf16_f32 v97, v98, v99
    v_cvt_pk_bf16_f32 v98, v100, v101
    v_cvt_pk_bf16_f32 v99, v102, v103
    buffer_store_dwordx4 v[96:99], v46, s[40:43], s68 offen offset:0 sc1
    v_pk_fma_f32 v[112:113], v[112:113], v[24:25], v[16:17]
    v_pk_fma_f32 v[114:115], v[114:115], v[26:27], v[18:19]
    v_pk_fma_f32 v[116:117], v[116:117], v[28:29], v[20:21]
    v_pk_fma_f32 v[118:119], v[118:119], v[30:31], v[22:23]
    v_cvt_pk_bf16_f32 v112, v112, v113
    v_cvt_pk_bf16_f32 v113, v114, v115
    v_cvt_pk_bf16_f32 v114, v116, v117
    v_cvt_pk_bf16_f32 v115, v118, v119
    buffer_store_dwordx4 v[112:115], v46, s[40:43], s69 offen offset:0 sc1
    v_lshlrev_b32 v16, 16, v160
    v_and_b32 v17, 0xffff0000, v160
    v_lshlrev_b32 v18, 16, v162
    v_and_b32 v19, 0xffff0000, v162
    v_lshlrev_b32 v20, 16, v164
    v_and_b32 v21, 0xffff0000, v164
    v_lshlrev_b32 v22, 16, v166
    v_and_b32 v23, 0xffff0000, v166
    v_lshlrev_b32 v24, 16, v168
    v_and_b32 v25, 0xffff0000, v168
    v_lshlrev_b32 v26, 16, v170
    v_and_b32 v27, 0xffff0000, v170
    v_lshlrev_b32 v28, 16, v172
    v_and_b32 v29, 0xffff0000, v172
    v_lshlrev_b32 v30, 16, v174
    v_and_b32 v31, 0xffff0000, v174
    v_pk_fma_f32 v[104:105], v[104:105], v[24:25], v[16:17]
    v_pk_fma_f32 v[106:107], v[106:107], v[26:27], v[18:19]
    v_pk_fma_f32 v[108:109], v[108:109], v[28:29], v[20:21]
    v_pk_fma_f32 v[110:111], v[110:111], v[30:31], v[22:23]
    v_cvt_pk_bf16_f32 v104, v104, v105
    v_cvt_pk_bf16_f32 v105, v106, v107
    v_cvt_pk_bf16_f32 v106, v108, v109
    v_cvt_pk_bf16_f32 v107, v110, v111
    buffer_store_dwordx4 v[104:107], v46, s[40:43], s68 offen offset:2048 sc1
    v_pk_fma_f32 v[120:121], v[120:121], v[24:25], v[16:17]
    v_pk_fma_f32 v[122:123], v[122:123], v[26:27], v[18:19]
    v_pk_fma_f32 v[124:125], v[124:125], v[28:29], v[20:21]
    v_pk_fma_f32 v[126:127], v[126:127], v[30:31], v[22:23]
    v_cvt_pk_bf16_f32 v120, v120, v121
    v_cvt_pk_bf16_f32 v121, v122, v123
    v_cvt_pk_bf16_f32 v122, v124, v125
    v_cvt_pk_bf16_f32 v123, v126, v127
    buffer_store_dwordx4 v[120:123], v46, s[40:43], s69 offen offset:2048 sc1
    s_lshl_b32 s14, s2, 2
    s_add_u32 s14, s14, s52
    s_mul_i32 s14, s14, 1408
    s_min_u32 s14, s14, 1407616
    s_add_u32 s14, s14, s20
    s_addc_u32 s15, s21, 0
    s_load_dword s35, s[14:15], 960
    s_load_dword s35, s[14:15], 1024
    s_load_dword s35, s[14:15], 1088
    s_load_dword s35, s[14:15], 1152
    s_load_dword s35, s[14:15], 1216
    s_load_dword s35, s[14:15], 1280
    s_load_dword s35, s[14:15], 1344
    s_lshl_b32 s64, s53, 2
    s_lshl_b32 s65, s52, 7
    s_add_u32 s64, s64, s65
    v_mov_b32 v24, s64
    s_add_u32 s92, s56, 1
    v_mov_b32 v25, s92
    v_and_b32 v27, 7, v0
    v_lshl_add_u32 v27, v27, 2, s65
    s_waitcnt vmcnt(0)
    s_cmp_eq_u32 s57, 0
    s_cbranch_scc1 L_st_1004s
    buffer_store_dword v25, v24, s[40:43], s93 offen offset:128
L_st_1004e:
    buffer_load_dword v28, v27, s[40:43], s93 offen offset:128 sc1
    s_sleep 2
    buffer_load_dword v29, v27, s[40:43], s93 offen offset:128 sc1
    s_sleep 2
    buffer_load_dword v30, v27, s[40:43], s93 offen offset:128 sc1
    s_sleep 2
L_pp_1005:
    buffer_load_dword v31, v27, s[40:43], s93 offen offset:128 sc1
    s_waitcnt vmcnt(3)
    v_subrev_u32 v26, s92, v28
    v_cmp_lt_u32 vcc, 7, v26
    s_cbranch_vccz L_pp_1005y
    s_sleep 2
    buffer_load_dword v28, v27, s[40:43], s93 offen offset:128 sc1
    s_waitcnt vmcnt(3)
    v_subrev_u32 v26, s92, v29
    v_cmp_lt_u32 vcc, 7, v26
    s_cbranch_vccz L_pp_1005y
    s_sleep 2
    buffer_load_dword v29, v27, s[40:43], s93 offen offset:128 sc1
    s_waitcnt vmcnt(3)
    v_subrev_u32 v26, s92, v30
    v_cmp_lt_u32 vcc, 7, v26
    s_cbranch_vccz L_pp_1005y
    s_sleep 2
    buffer_load_dword v30, v27, s[40:43], s93 offen offset:128 sc1
    s_waitcnt vmcnt(3)
    v_subrev_u32 v26, s92, v31
    v_cmp_lt_u32 vcc, 7, v26
    s_cbranch_vccz L_pp_1005y
    s_sleep 2
    s_sub_u32 s59, s59, 1
    s_cbranch_scc0 L_pp_1005
    s_mov_b32 s59, 0
L_pp_1005y:
    s_add_u32 m0, s62, 0
    s_nop 0
    buffer_load_dwordx4 v1, s[40:43], s80 offen offset:0 sc1 lds
    buffer_load_dwordx4 v1, s[40:43], s80 offen offset:1024 sc1 lds
    buffer_load_dwordx4 v1, s[40:43], s80 offen offset:2048 sc1 lds
    buffer_load_dwordx4 v1, s[40:43], s80 offen offset:3072 sc1 lds
    s_add_u32 m0, s62, 16384
    s_nop 0
    buffer_load_dwordx4 v1, s[40:43], s81 offen offset:0 sc1 lds
    buffer_load_dwordx4 v1, s[40:43], s81 offen offset:1024 sc1 lds
    buffer_load_dwordx4 v1, s[40:43], s81 offen offset:2048 sc1 lds
    buffer_load_dwordx4 v1, s[40:43], s81 offen offset:3072 sc1 lds
L_wf_1006:
    ds_read_b128 v[8:11], v72
    s_waitcnt lgkmcnt(0)
    v_min3_u32 v8, v8, v9, v10
    v_min_u32 v8, v8, v11
    v_cmp_gt_u32 vcc, 7, v8
    s_cbranch_vccnz L_wf_1006r
L_wf_1006y:
    s_add_u32 m0, s62, 32768
    s_nop 0
    buffer_load_dwordx4 v1, s[40:43], s82 offen offset:0 sc1 lds
    buffer_load_dwordx4 v1, s[40:43], s82 offen offset:1024 sc1 lds
    buffer_load_dwordx4 v1, s[40:43], s82 offen offset:2048 sc1 lds
    buffer_load_dwordx4 v1, s[40:43], s82 offen offset:3072 sc1 lds
    s_waitcnt vmcnt(8)
    s_barrier
    s_setprio 2
    s_lshl_b32 s64, s54, 2
    s_add_u32 s64, s64, s52
    s_lshl_b32 s64, s64, 14
    s_lshl_b32 s65, s53, 7
    s_add_u32 s64, s64, s65
    s_add_u32 s65, s64, 7168
    s_lshr_b32 s71, s62, 1
    s_add_u32 m0, s71, 147456
    s_nop 0
    buffer_load_dwordx4 v47, s[44:47], s64 offen lds
    buffer_load_dwordx4 v47, s[44:47], s65 offen offset:1024 lds
    s_mov_b64 s[36:37], s[12:13]
    s_add_u32 m0, s62, 114688
    s_nop 0
    buffer_load_dwordx4 v40, s[36:39], s78 offen offset:0 lds
    buffer_load_dwordx4 v41, s[36:39], s78 offen offset:1024 lds
    buffer_load_dwordx4 v42, s[36:39], s78 offen offset:2048 lds
    buffer_load_dwordx4 v43, s[36:39], s78 offen offset:3072 lds
    s_mov_b64 s[36:37], s[12:13]
    s_add_u32 m0, s62, 131072
    s_nop 0
    buffer_load_dwordx4 v40, s[36:39], s79 offen offset:0 lds
    buffer_load_dwordx4 v41, s[36:39], s79 offen offset:1024 lds
    buffer_load_dwordx4 v42, s[36:39], s79 offen offset:2048 lds
    buffer_load_dwordx4 v43, s[36:39], s79 offen offset:3072 lds
    s_waitcnt vmcnt(14)
    s_waitcnt lgkmcnt(0)
    s_barrier
    s_add_u32 m0, s62, 49152
    s_nop 0
    buffer_load_dwordx4 v1, s[40:43], s83 offen offset:0 sc1 lds
    buffer_load_dwordx4 v1, s[40:43], s83 offen offset:1024 sc1 lds
    buffer_load_dwordx4 v1, s[40:43], s83 offen offset:2048 sc1 lds
    buffer_load_dwordx4 v1, s[40:43], s83 offen offset:3072 sc1 lds
    ds_read_b64_tr_b16 v[128:129], v3 offset:0
    ds_read_b64_tr_b16 v[130:131], v3 offset:512
    ds_read_b64_tr_b16 v[132:133], v3 offset:4096
    ds_read_b64_tr_b16 v[134:135], v3 offset:4608
    ds_read_b64_tr_b16 v[136:137], v3 offset:8192
    ds_read_b64_tr_b16 v[138:139], v3 offset:8704
    ds_read_b64_tr_b16 v[140:141], v3 offset:12288
    ds_read_b64_tr_b16 v[142:143], v3 offset:12800
    ds_read_b64_tr_b16 v[144:145], v3 offset:16384
    ds_read_b64_tr_b16 v[146:147], v3 offset:16896
    ds_read_b64_tr_b16 v[148:149], v3 offset:20480
    ds_read_b64_tr_b16 v[150:151], v3 offset:20992
    ds_read_b64_tr_b16 v[152:153], v3 offset:24576
    ds_read_b64_tr_b16 v[154:155], v3 offset:25088
    ds_read_b64_tr_b16 v[156:157], v3 offset:28672
    ds_read_b64_tr_b16 v[158:159], v3 offset:29184
    s_add_u32 m0, s62, 65536
    s_nop 0
    buffer_load_dwordx4 v1, s[40:43], s84 offen offset:0 sc1 lds
    buffer_load_dwordx4 v1, s[40:43], s84 offen offset:1024 sc1 lds
    buffer_load_dwordx4 v1, s[40:43], s84 offen offset:2048 sc1 lds
    buffer_load_dwordx4 v1, s[40:43], s84 offen offset:3072 sc1 lds
    s_waitcnt vmcnt(8)
    s_waitcnt lgkmcnt(0)
    s_barrier
    s_mov_b64 s[36:37], s[16:17]
    s_add_u32 m0, s62, 81920
    s_nop 0
    buffer_load_dwordx4 v40, s[36:39], s76 offen offset:0 lds
    buffer_load_dwordx4 v41, s[36:39], s76 offen offset:1024 lds
    buffer_load_dwordx4 v42, s[36:39], s76 offen offset:2048 lds
    buffer_load_dwordx4 v43, s[36:39], s76 offen offset:3072 lds
    s_mov_b64 s[36:37], s[16:17]
    s_add_u32 m0, s62, 98304
    s_nop 0
    buffer_load_dwordx4 v40, s[36:39], s77 offen offset:0 lds
    buffer_load_dwordx4 v41, s[36:39], s77 offen offset:1024 lds
    buffer_load_dwordx4 v42, s[36:39], s77 offen offset:2048 lds
    buffer_load_dwordx4 v43, s[36:39], s77 offen offset:3072 lds
    ds_read_b64_tr_b16 v[160:161], v3 offset:32768
    ds_read_b64_tr_b16 v[162:163], v3 offset:33280
    ds_read_b64_tr_b16 v[164:165], v3 offset:36864
    ds_read_b64_tr_b16 v[166:167], v3 offset:37376
    ds_read_b64_tr_b16 v[168:169], v3 offset:40960
    ds_read_b64_tr_b16 v[170:171], v3 offset:41472
    ds_read_b64_tr_b16 v[172:173], v3 offset:45056
    ds_read_b64_tr_b16 v[174:175], v3 offset:45568
    ds_read_b64_tr_b16 v[176:177], v3 offset:49152
    ds_read_b64_tr_b16 v[178:179], v3 offset:49664
    ds_read_b64_tr_b16 v[180:181], v3 offset:53248
    ds_read_b64_tr_b16 v[182:183], v3 offset:53760
    ds_read_b64_tr_b16 v[184:185], v3 offset:57344
    ds_read_b64_tr_b16 v[186:187], v3 offset:57856
    ds_read_b64_tr_b16 v[188:189], v3 offset:61440
    ds_read_b64_tr_b16 v[190:191], v3 offset:61952
    s_mov_b64 s[36:37], s[18:19]
    s_add_u32 m0, s62, 0
    s_nop 0
    buffer_load_dwordx4 v40, s[36:39], s85 offen offset:0 lds
    buffer_load_dwordx4 v41, s[36:39], s85 offen offset:1024 lds
    buffer_load_dwordx4 v42, s[36:39], s85 offen offset:2048 lds
    buffer_load_dwordx4 v43, s[36:39], s85 offen offset:3072 lds
    s_waitcnt vmcnt(16)
    s_waitcnt lgkmcnt(0)
    s_barrier
    s_lshl_b32 s14, s2, 2
    s_add_u32 s14, s14, s52
    s_mul_i32 s14, s14, 1408
    s_min_u32 s14, s14, 1407616
    s_add_u32 s14, s14, s22
    s_addc_u32 s15, s23, 0
    s_load_dword s35, s[14:15], 0
    s_load_dword s35, s[14:15], 64
    s_load_dword s35, s[14:15], 128
    s_load_dword s35, s[14:15], 192
    s_load_dword s35, s[14:15], 256
    s_load_dword s35, s[14:15], 320
    s_load_dword s35, s[14:15], 384
    s_load_dword s35, s[14:15], 448
    s_load_dword s35, s[14:15], 512
    s_load_dword s35, s[14:15], 576
    s_load_dword s35, s[14:15], 640
    s_load_dword s35, s[14:15], 704
    s_load_dword s35, s[14:15], 768
    s_load_dword s35, s[14:15], 832
    s_load_dword s35, s[14:15], 896
    s_mov_b64 s[36:37], s[16:17]
    s_add_u32 m0, s62, 114688
    s_nop 0
    buffer_load_dwordx4 v40, s[36:39], s78 offen offset:0 lds
    buffer_load_dwordx4 v41, s[36:39], s78 offen offset:1024 lds
    buffer_load_dwordx4 v42, s[36:39], s78 offen offset:2048 lds
    buffer_load_dwordx4 v43, s[36:39], s78 offen offset:3072 lds
    s_mov_b64 s[36:37], s[16:17]
    s_add_u32 m0, s62, 131072
    s_nop 0
    buffer_load_dwordx4 v40, s[36:39], s79 offen offset:0 lds
    buffer_load_dwordx4 v41, s[36:39], s79 offen offset:1024 lds
    buffer_load_dwordx4 v42, s[36:39], s79 offen offset:2048 lds
    buffer_load_dwordx4 v43, s[36:39], s79 offen offset:3072 lds
    s_mov_b64 s[36:37], s[18:19]
    s_add_u32 m0, s62, 16384
    s_nop 0
    buffer_load_dwordx4 v40, s[36:39], s86 offen offset:0 lds
    buffer_load_dwordx4 v41, s[36:39], s86 offen offset:1024 lds
    buffer_load_dwordx4 v42, s[36:39], s86 offen offset:2048 lds
    buffer_load_dwordx4 v43, s[36:39], s86 offen offset:3072 lds
    s_waitcnt vmcnt(24)
    s_barrier
    s_mov_b64 s[36:37], s[18:19]
    s_add_u32 m0, s62, 32768
    s_nop 0
    buffer_load_dwordx4 v40, s[36:39], s87 offen offset:0 lds
    buffer_load_dwordx4 v41, s[36:39], s87 offen offset:1024 lds
    buffer_load_dwordx4 v42, s[36:39], s87 offen offset:2048 lds
    buffer_load_dwordx4 v43, s[36:39], s87 offen offset:3072 lds
    buffer_load_dwordx4 v[16:19], v74, s[40:43], s66 offen sc1
    buffer_load_dwordx4 v[20:23], v74, s[40:43], s67 offen sc1
    s_barrier
    s_mov_b64 s[36:37], s[18:19]
    s_add_u32 m0, s62, 49152
    s_nop 0
    buffer_load_dwordx4 v40, s[36:39], s88 offen offset:0 lds
    buffer_load_dwordx4 v41, s[36:39], s88 offen offset:1024 lds
    buffer_load_dwordx4 v42, s[36:39], s88 offen offset:2048 lds
    buffer_load_dwordx4 v43, s[36:39], s88 offen offset:3072 lds
    s_add_u32 s64, s4, s52
    s_add_u32 s64, s64, 0
    s_and_b32 s64, s64, 15
    s_lshl_b32 s64, s64, 12
    s_add_u32 s64, s64, s58
    s_add_u32 s80, s64, 0x10000
    s_add_u32 s64, s4, s52
    s_add_u32 s64, s64, 4
    s_and_b32 s64, s64, 15
    s_lshl_b32 s64, s64, 12
    s_add_u32 s64, s64, s58
    s_add_u32 s81, s64, 0x10000
    s_add_u32 s64, s4, s52
    s_add_u32 s64, s64, 8
    s_and_b32 s64, s64, 15
    s_lshl_b32 s64, s64, 12
    s_add_u32 s64, s64, s58
    s_add_u32 s82, s64, 0x10000
    s_add_u32 s64, s4, s52
    s_add_u32 s64, s64, 12
    s_and_b32 s64, s64, 15
    s_lshl_b32 s64, s64, 12
    s_add_u32 s64, s64, s58
    s_add_u32 s83, s64, 0x10000
    s_getpc_b64 s[48:49]
L_ct_1007:
    s_sub_u32 s48, s48, L_ct_1007-L_pc
    s_subb_u32 s49, s49, 0
    s_mov_b32 s50, L_codeend-L_pc
    s_mov_b32 s51, 0x20000
    s_lshr_b32 s95, s2, 3
    s_lshl_b32 s95, s95, 2
    s_add_u32 s95, s95, s52
    s_lshl_b32 s95, s95, 9
    v_min_u32 v125, 3, v0
    v_lshlrev_b32 v125, 7, v125
    buffer_load_dword v127, v125, s[48:51], s95 offen
    ds_read_b64 v[64:65], v76 offset:0
    ds_read_b64 v[66:67], v76 offset:2048
    ds_read_b64 v[68:69], v76 offset:4096
    ds_read_b64 v[70:71], v76 offset:6144
    s_waitcnt vmcnt(5)
L_pl_1008c:
    v_xor_b32 v32, s56, v17
    v_xor_b32 v33, s56, v19
    v_xor_b32 v34, s56, v21
    v_xor_b32 v35, s56, v23
    v_or3_b32 v32, v32, v33, v34
    v_or_b32 v32, v32, v35
    v_cmp_ne_u32 vcc, 0, v32
    s_cbranch_vccnz L_pl_1008r
L_pl_1008y:
    v_add_u32 v73, 2048, v73
    ds_write2_b32 v73, v16, v18 offset0:0 offset1:1
    v_add_u32 v73, 2048, v73
    ds_write2_b32 v73, v20, v22 offset0:0 offset1:1
    v_mov_b32 v8, v40
    v_mov_b32 v9, v41
    v_mov_b32 v10, v42
    v_mov_b32 v11, v43
    v_mov_b32 v72, v84
    v_mov_b32 v73, v85
    v_mov_b32 v74, v86
    s_branch L_pg_1009
.p2align 12
L_pg_1009:
    s_add_u32 s70, s58, 0x10000
    s_waitcnt vmcnt(0) lgkmcnt(0)
    s_barrier
    s_setprio 1
    ds_read_b64_tr_b16 v[192:193], v4 offset:0
    ds_read_b64_tr_b16 v[194:195], v4 offset:512
    ds_read_b64_tr_b16 v[196:197], v4 offset:4096
    ds_read_b64_tr_b16 v[198:199], v4 offset:4608
    ds_read_b64_tr_b16 v[200:201], v4 offset:8192
    ds_read_b64_tr_b16 v[202:203], v4 offset:8704
    ds_read_b64_tr_b16 v[204:205], v4 offset:12288
    ds_read_b64_tr_b16 v[206:207], v4 offset:12800
    ds_read_b64_tr_b16 v[208:209], v4 offset:16384
    ds_read_b64_tr_b16 v[210:211], v4 offset:16896
    ds_read_b64_tr_b16 v[212:213], v4 offset:20480
    ds_read_b64_tr_b16 v[214:215], v4 offset:20992
    ds_read_b64_tr_b16 v[216:217], v4 offset:24576
    ds_read_b64_tr_b16 v[218:219], v4 offset:25088
    ds_read_b64_tr_b16 v[220:221], v4 offset:28672
    ds_read_b64_tr_b16 v[222:223], v4 offset:29184
    ds_read_b64_tr_b16 v[224:225], v4 offset:32768
    ds_read_b64_tr_b16 v[226:227], v4 offset:33280
    ds_read_b64_tr_b16 v[228:229], v4 offset:36864
    ds_read_b64_tr_b16 v[230:231], v4 offset:37376
    ds_read_b64_tr_b16 v[232:233], v4 offset:40960
    ds_read_b64_tr_b16 v[234:235], v4 offset:41472
    ds_read_b64_tr_b16 v[236:237], v4 offset:45056
    ds_read_b64_tr_b16 v[238:239], v4 offset:45568
    ds_read_b64_tr_b16 v[240:241], v4 offset:49152
    ds_read_b64_tr_b16 v[242:243], v4 offset:49664
    ds_read_b64_tr_b16 v[244:245], v4 offset:53248
    ds_read_b64_tr_b16 v[246:247], v4 offset:53760
    ds_read_b64_tr_b16 v[248:249], v4 offset:57344
    ds_read_b64_tr_b16 v[250:251], v4 offset:57856
    ds_read_b64_tr_b16 v[252:253], v4 offset:61440
    ds_read_b64_tr_b16 v[254:255], v4 offset:61952
    s_waitcnt lgkmcnt(0)
    s_barrier
    s_or_b32 s64, s2, s52
    s_cmp_lg_u32 s64, 0
    s_cbranch_scc1 L_ep_1010
    v_mov_b32 v124, 16384
    v_mov_b32 v125, s56
    buffer_store_dword v125, v124, s[40:43], 0 offen sc1
L_ep_1010:
    ds_read_b128 v[20:23], v75 offset:3072
    ds_read_b128 v[28:31], v75 offset:4096
    ds_read_b64 v[32:33], v77 offset:2048
    ds_read_b64 v[34:35], v77 offset:3072
    ds_read_b64 v[36:37], v77 offset:4096
    ds_read_b64 v[38:39], v77 offset:5120
    s_waitcnt lgkmcnt(0)
    v_lshlrev_b32 v48, 16, v64
    v_and_b32 v49, 0xffff0000, v64
    v_lshlrev_b32 v50, 16, v65
    v_and_b32 v51, 0xffff0000, v65
    v_lshlrev_b32 v52, 16, v66
    v_and_b32 v53, 0xffff0000, v66
    v_lshlrev_b32 v54, 16, v67
    v_and_b32 v55, 0xffff0000, v67
    v_lshlrev_b32 v56, 16, v68
    v_and_b32 v57, 0xffff0000, v68
    v_lshlrev_b32 v58, 16, v69
    v_and_b32 v59, 0xffff0000, v69
    v_lshlrev_b32 v60, 16, v70
    v_and_b32 v61, 0xffff0000, v70
    v_lshlrev_b32 v62, 16, v71
    v_and_b32 v63, 0xffff0000, v71
    s_cmp_eq_u32 s52, 1
    s_cselect_b64 s[72:73], -1, 0
    s_cmp_ge_u32 s52, 2
    s_cselect_b64 s[74:75], -1, 0
    v_mov_b32 v24, 0x3f803f80
    s_min_u32 s65, s52, 2
    s_lshl_b32 s65, s65, 10
    v_add_u32 v12, s65, v12
    v_cndmask_b32 v28, v28, v20, s[72:73]
    v_cndmask_b32 v29, v29, v21, s[72:73]
    v_cndmask_b32 v30, v30, v22, s[72:73]
    v_cndmask_b32 v31, v31, v23, s[72:73]
    v_cndmask_b32 v28, v28, v24, s[74:75]
    v_cndmask_b32 v29, v29, v24, s[74:75]
    v_cndmask_b32 v30, v30, v24, s[74:75]
    v_cndmask_b32 v31, v31, v24, s[74:75]
    ds_write_b128 v12, v[28:31]
    v_lshlrev_b32 v84, 16, v32
    v_and_b32 v85, 0xffff0000, v32
    v_lshlrev_b32 v86, 16, v33
    v_and_b32 v87, 0xffff0000, v33
    v_lshlrev_b32 v92, 16, v34
    v_and_b32 v93, 0xffff0000, v34
    v_lshlrev_b32 v94, 16, v35
    v_and_b32 v95, 0xffff0000, v35
    v_lshlrev_b32 v88, 16, v36
    v_and_b32 v89, 0xffff0000, v36
    v_lshlrev_b32 v90, 16, v37
    v_and_b32 v91, 0xffff0000, v37
    v_lshlrev_b32 v80, 16, v38
    v_and_b32 v81, 0xffff0000, v38
    v_lshlrev_b32 v82, 16, v39
    v_and_b32 v83, 0xffff0000, v39
    s_lshl_b32 s65, s52, 2
    s_add_u32 s65, s65, 155648
    v_add_u32 v12, s65, v1
    s_waitcnt lgkmcnt(0)
    s_barrier
    ds_read_b128 v[16:19], v5 offset:0
    ds_read_b128 v[20:23], v5 offset:256
    ds_read_b128 v[24:27], v5 offset:512
    ds_read_b128 v[28:31], v5 offset:768
    ds_read_b128 v[112:115], v5 offset:1024
    ds_read_b128 v[116:119], v5 offset:1280
    ds_read_b128 v[120:123], v5 offset:1536
    ds_read_b128 v[124:127], v5 offset:1792
    s_waitcnt lgkmcnt(6)
    v_mfma_f32_16x16x32_bf16 v[32:35], v[128:131], v[16:19], 0
    ds_read_b128 v[16:19], v5 offset:2048
    v_mfma_f32_16x16x32_bf16 v[36:39], v[128:131], v[20:23], 0
    ds_read_b128 v[20:23], v5 offset:2304
    s_waitcnt lgkmcnt(6)
    v_mfma_f32_16x16x32_bf16 v[40:43], v[128:131], v[24:27], 0
    ds_read_b128 v[24:27], v5 offset:2560
    v_mfma_f32_16x16x32_bf16 v[44:47], v[128:131], v[28:31], 0
    ds_read_b128 v[28:31], v5 offset:2816
    s_waitcnt lgkmcnt(6)
    v_mfma_f32_16x16x32_bf16 v[32:35], v[132:135], v[112:115], v[32:35]
    ds_read_b128 v[112:115], v5 offset:3072
    v_mfma_f32_16x16x32_bf16 v[36:39], v[132:135], v[116:119], v[36:39]
    ds_read_b128 v[116:119], v5 offset:3328
    s_waitcnt lgkmcnt(6)
    v_mfma_f32_16x16x32_bf16 v[40:43], v[132:135], v[120:123], v[40:43]
    ds_read_b128 v[120:123], v5 offset:3584
    v_mfma_f32_16x16x32_bf16 v[44:47], v[132:135], v[124:127], v[44:47]
    ds_read_b128 v[124:127], v5 offset:3840
    s_waitcnt lgkmcnt(6)
    v_mfma_f32_16x16x32_bf16 v[32:35], v[136:139], v[16:19], v[32:35]
    s_barrier
    ds_read_b128 v[16:19], v5 offset:16384
    v_mfma_f32_16x16x32_bf16 v[36:39], v[136:139], v[20:23], v[36:39]
    ds_read_b128 v[20:23], v5 offset:16640
    s_waitcnt lgkmcnt(6)
    v_mfma_f32_16x16x32_bf16 v[40:43], v[136:139], v[24:27], v[40:43]
    ds_read_b128 v[24:27], v5 offset:16896
    v_mfma_f32_16x16x32_bf16 v[44:47], v[136:139], v[28:31], v[44:47]
    ds_read_b128 v[28:31], v5 offset:17152
    s_waitcnt lgkmcnt(6)
    v_mfma_f32_16x16x32_bf16 v[32:35], v[140:143], v[112:115], v[32:35]
    ds_read_b128 v[112:115], v5 offset:17408
    v_mfma_f32_16x16x32_bf16 v[36:39], v[140:143], v[116:119], v[36:39]
    ds_read_b128 v[116:119], v5 offset:17664
    s_waitcnt lgkmcnt(6)
    v_mfma_f32_16x16x32_bf16 v[40:43], v[140:143], v[120:123], v[40:43]
    ds_read_b128 v[120:123], v5 offset:17920
    v_mfma_f32_16x16x32_bf16 v[44:47], v[140:143], v[124:127], v[44:47]
    ds_read_b128 v[124:127], v5 offset:18176
    s_waitcnt lgkmcnt(6)
    v_mfma_f32_16x16x32_bf16 v[32:35], v[144:147], v[16:19], v[32:35]
    ds_read_b128 v[16:19], v5 offset:18432
    v_mfma_f32_16x16x32_bf16 v[36:39], v[144:147], v[20:23], v[36:39]
    ds_read_b128 v[20:23], v5 offset:18688
    s_waitcnt lgkmcnt(6)
    v_mfma_f32_16x16x32_bf16 v[40:43], v[144:147], v[24:27], v[40:43]
    ds_read_b128 v[24:27], v5 offset:18944
    v_mfma_f32_16x16x32_bf16 v[44:47], v[144:147], v[28:31], v[44:47]
    ds_read_b128 v[28:31], v5 offset:19200
    s_waitcnt lgkmcnt(6)
    v_mfma_f32_16x16x32_bf16 v[32:35], v[148:151], v[112:115], v[32:35]
    ds_read_b128 v[112:115], v5 offset:19456
    v_mfma_f32_16x16x32_bf16 v[36:39], v[148:151], v[116:119], v[36:39]
    ds_read_b128 v[116:119], v5 offset:19712
    s_waitcnt lgkmcnt(6)
    v_mfma_f32_16x16x32_bf16 v[40:43], v[148:151], v[120:123], v[40:43]
    ds_read_b128 v[120:123], v5 offset:19968
    v_mfma_f32_16x16x32_bf16 v[44:47], v[148:151], v[124:127], v[44:47]
    ds_read_b128 v[124:127], v5 offset:20224
    s_waitcnt lgkmcnt(6)
    v_mfma_f32_16x16x32_bf16 v[32:35], v[152:155], v[16:19], v[32:35]
    s_barrier
    ds_read_b128 v[16:19], v5 offset:32768
    v_mfma_f32_16x16x32_bf16 v[36:39], v[152:155], v[20:23], v[36:39]
    ds_read_b128 v[20:23], v5 offset:33024
    s_waitcnt lgkmcnt(6)
    v_mfma_f32_16x16x32_bf16 v[40:43], v[152:155], v[24:27], v[40:43]
    ds_read_b128 v[24:27], v5 offset:33280
    v_mfma_f32_16x16x32_bf16 v[44:47], v[152:155], v[28:31], v[44:47]
    ds_read_b128 v[28:31], v5 offset:33536
    s_waitcnt lgkmcnt(6)
    v_mfma_f32_16x16x32_bf16 v[32:35], v[156:159], v[112:115], v[32:35]
    ds_read_b128 v[112:115], v5 offset:33792
    v_mfma_f32_16x16x32_bf16 v[36:39], v[156:159], v[116:119], v[36:39]
    ds_read_b128 v[116:119], v5 offset:34048
    s_waitcnt lgkmcnt(6)
    v_mfma_f32_16x16x32_bf16 v[40:43], v[156:159], v[120:123], v[40:43]
    ds_read_b128 v[120:123], v5 offset:34304
    v_mfma_f32_16x16x32_bf16 v[44:47], v[156:159], v[124:127], v[44:47]
    ds_read_b128 v[124:127], v5 offset:34560
    s_waitcnt lgkmcnt(6)
    v_mfma_f32_16x16x32_bf16 v[32:35], v[160:163], v[16:19], v[32:35]
    ds_read_b128 v[16:19], v5 offset:34816
    v_mfma_f32_16x16x32_bf16 v[36:39], v[160:163], v[20:23], v[36:39]
    ds_read_b128 v[20:23], v5 offset:35072
    s_waitcnt lgkmcnt(6)
    v_mfma_f32_16x16x32_bf16 v[40:43], v[160:163], v[24:27], v[40:43]
    ds_read_b128 v[24:27], v5 offset:35328
    v_mfma_f32_16x16x32_bf16 v[44:47], v[160:163], v[28:31], v[44:47]
    ds_read_b128 v[28:31], v5 offset:35584
    s_waitcnt lgkmcnt(6)
    v_mfma_f32_16x16x32_bf16 v[32:35], v[164:167], v[112:115], v[32:35]
    ds_read_b128 v[112:115], v5 offset:35840
    v_mfma_f32_16x16x32_bf16 v[36:39], v[164:167], v[116:119], v[36:39]
    ds_read_b128 v[116:119], v5 offset:36096
    s_waitcnt lgkmcnt(6)
    v_mfma_f32_16x16x32_bf16 v[40:43], v[164:167], v[120:123], v[40:43]
    ds_read_b128 v[120:123], v5 offset:36352
    v_mfma_f32_16x16x32_bf16 v[44:47], v[164:167], v[124:127], v[44:47]
    ds_read_b128 v[124:127], v5 offset:36608
    s_waitcnt lgkmcnt(6)
    v_mfma_f32_16x16x32_bf16 v[32:35], v[168:171], v[16:19], v[32:35]
    s_barrier
    ds_read_b128 v[16:19], v5 offset:49152
    v_mfma_f32_16x16x32_bf16 v[36:39], v[168:171], v[20:23], v[36:39]
    ds_read_b128 v[20:23], v5 offset:49408
    s_waitcnt lgkmcnt(6)
    v_mfma_f32_16x16x32_bf16 v[40:43], v[168:171], v[24:27], v[40:43]
    ds_read_b128 v[24:27], v5 offset:49664
    v_mfma_f32_16x16x32_bf16 v[44:47], v[168:171], v[28:31], v[44:47]
    ds_read_b128 v[28:31], v5 offset:49920
    s_waitcnt lgkmcnt(6)
    v_mfma_f32_16x16x32_bf16 v[32:35], v[172:175], v[112:115], v[32:35]
    ds_read_b128 v[112:115], v5 offset:50176
    v_mfma_f32_16x16x32_bf16 v[36:39], v[172:175], v[116:119], v[36:39]
    ds_read_b128 v[116:119], v5 offset:50432
    s_waitcnt lgkmcnt(6)
    v_mfma_f32_16x16x32_bf16 v[40:43], v[172:175], v[120:123], v[40:43]
    ds_read_b128 v[120:123], v5 offset:50688
    v_mfma_f32_16x16x32_bf16 v[44:47], v[172:175], v[124:127], v[44:47]
    ds_read_b128 v[124:127], v5 offset:50944
    s_waitcnt lgkmcnt(6)
    v_mfma_f32_16x16x32_bf16 v[32:35], v[176:179], v[16:19], v[32:35]
    ds_read_b128 v[16:19], v5 offset:51200
    v_mfma_f32_16x16x32_bf16 v[36:39], v[176:179], v[20:23], v[36:39]
    ds_read_b128 v[20:23], v5 offset:51456
    s_waitcnt lgkmcnt(6)
    v_mfma_f32_16x16x32_bf16 v[40:43], v[176:179], v[24:27], v[40:43]
    ds_read_b128 v[24:27], v5 offset:51712
    v_mfma_f32_16x16x32_bf16 v[44:47], v[176:179], v[28:31], v[44:47]
    ds_read_b128 v[28:31], v5 offset:51968
    s_waitcnt lgkmcnt(6)
    v_mfma_f32_16x16x32_bf16 v[32:35], v[180:183], v[112:115], v[32:35]
    ds_read_b128 v[112:115], v5 offset:52224
    v_mfma_f32_16x16x32_bf16 v[36:39], v[180:183], v[116:119], v[36:39]
    ds_read_b128 v[116:119], v5 offset:52480
    s_waitcnt lgkmcnt(6)
    v_mfma_f32_16x16x32_bf16 v[40:43], v[180:183], v[120:123], v[40:43]
    ds_read_b128 v[120:123], v5 offset:52736
    v_mfma_f32_16x16x32_bf16 v[44:47], v[180:183], v[124:127], v[44:47]
    ds_read_b128 v[124:127], v5 offset:52992
    s_waitcnt lgkmcnt(6)
    v_mfma_f32_16x16x32_bf16 v[32:35], v[184:187], v[16:19], v[32:35]
    v_mfma_f32_16x16x32_bf16 v[36:39], v[184:187], v[20:23], v[36:39]
    s_waitcnt lgkmcnt(4)
    v_mfma_f32_16x16x32_bf16 v[40:43], v[184:187], v[24:27], v[40:43]
    v_mfma_f32_16x16x32_bf16 v[44:47], v[184:187], v[28:31], v[44:47]
    s_waitcnt lgkmcnt(2)
    v_mfma_f32_16x16x32_bf16 v[32:35], v[188:191], v[112:115], v[32:35]
    v_mfma_f32_16x16x32_bf16 v[36:39], v[188:191], v[116:119], v[36:39]
    s_waitcnt lgkmcnt(0)
    v_mfma_f32_16x16x32_bf16 v[40:43], v[188:191], v[120:123], v[40:43]
    v_mfma_f32_16x16x32_bf16 v[44:47], v[188:191], v[124:127], v[44:47]
    s_setprio 3
    s_nop 2
    v_pk_fma_f32 v[48:49], v[32:33], v[84:85], v[48:49]
    v_pk_fma_f32 v[50:51], v[34:35], v[86:87], v[50:51]
    v_pk_fma_f32 v[52:53], v[36:37], v[84:85], v[52:53]
    v_pk_fma_f32 v[54:55], v[38:39], v[86:87], v[54:55]
    v_pk_fma_f32 v[56:57], v[40:41], v[84:85], v[56:57]
    v_pk_fma_f32 v[58:59], v[42:43], v[86:87], v[58:59]
    v_pk_fma_f32 v[60:61], v[44:45], v[84:85], v[60:61]
    v_pk_fma_f32 v[62:63], v[46:47], v[86:87], v[62:63]
    v_pk_mul_f32 v[32:33], v[48:49], v[88:89]
    v_pk_mul_f32 v[34:35], v[50:51], v[90:91]
    v_pk_mul_f32 v[36:37], v[52:53], v[88:89]
    v_pk_mul_f32 v[38:39], v[54:55], v[90:91]
    v_pk_mul_f32 v[40:41], v[56:57], v[88:89]
    v_pk_mul_f32 v[42:43], v[58:59], v[90:91]
    v_pk_mul_f32 v[44:45], v[60:61], v[88:89]
    v_pk_mul_f32 v[46:47], v[62:63], v[90:91]
    v_cvt_pk_bf16_f32 v16, v32, v33
    v_cvt_pk_bf16_f32 v17, v34, v35
    v_cvt_pk_bf16_f32 v18, v36, v37
    v_cvt_pk_bf16_f32 v19, v38, v39
    v_cvt_pk_bf16_f32 v20, v40, v41
    v_cvt_pk_bf16_f32 v21, v42, v43
    v_cvt_pk_bf16_f32 v22, v44, v45
    v_cvt_pk_bf16_f32 v23, v46, v47
    v_permlane16_swap_b32 v16, v18
    v_permlane16_swap_b32 v17, v19
    v_permlane16_swap_b32 v20, v22
    v_permlane16_swap_b32 v21, v23
    s_cmp_eq_u32 s57, 0
    s_cbranch_scc1 L_st_1011s
    buffer_store_dwordx4 v[16:19], v6, s[40:43], s70 offen
    buffer_store_dwordx4 v[20:23], v6, s[40:43], s70 offen offset:512
L_st_1011e:
    v_pk_add_f32 v[96:97], v[48:49], v[50:51]
    v_pk_add_f32 v[98:99], v[52:53], v[54:55]
    v_pk_add_f32 v[100:101], v[56:57], v[58:59]
    v_pk_add_f32 v[102:103], v[60:61], v[62:63]
    v_add_f32 v104, v96, v97
    v_add_f32 v105, v98, v99
    v_add_f32 v106, v100, v101
    v_add_f32 v107, v102, v103
    v_pk_mul_f32 v[96:97], v[48:49], v[48:49]
    v_pk_mul_f32 v[98:99], v[52:53], v[52:53]
    v_pk_mul_f32 v[100:101], v[56:57], v[56:57]
    v_pk_mul_f32 v[102:103], v[60:61], v[60:61]
    v_pk_fma_f32 v[96:97], v[50:51], v[50:51], v[96:97]
    v_pk_fma_f32 v[98:99], v[54:55], v[54:55], v[98:99]
    v_pk_fma_f32 v[100:101], v[58:59], v[58:59], v[100:101]
    v_pk_fma_f32 v[102:103], v[62:63], v[62:63], v[102:103]
    v_add_f32 v108, v96, v97
    v_add_f32 v109, v98, v99
    v_add_f32 v110, v100, v101
    v_add_f32 v111, v102, v103
    v_pk_add_f32 v[96:97], v[32:33], v[34:35]
    v_pk_add_f32 v[98:99], v[36:37], v[38:39]
    v_pk_add_f32 v[100:101], v[40:41], v[42:43]
    v_pk_add_f32 v[102:103], v[44:45], v[46:47]
    v_add_f32 v112, v96, v97
    v_add_f32 v113, v98, v99
    v_add_f32 v114, v100, v101
    v_add_f32 v115, v102, v103
    v_pk_mul_f32 v[96:97], v[32:33], v[32:33]
    v_pk_mul_f32 v[98:99], v[36:37], v[36:37]
    v_pk_mul_f32 v[100:101], v[40:41], v[40:41]
    v_pk_mul_f32 v[102:103], v[44:45], v[44:45]
    v_pk_fma_f32 v[96:97], v[34:35], v[34:35], v[96:97]
    v_pk_fma_f32 v[98:99], v[38:39], v[38:39], v[98:99]
    v_pk_fma_f32 v[100:101], v[42:43], v[42:43], v[100:101]
    v_pk_fma_f32 v[102:103], v[46:47], v[46:47], v[102:103]
    v_add_f32 v116, v96, v97
    v_add_f32 v117, v98, v99
    v_add_f32 v118, v100, v101
    v_add_f32 v119, v102, v103
    v_pk_mul_f32 v[96:97], v[32:33], v[88:89]
    v_pk_mul_f32 v[98:99], v[36:37], v[88:89]
    v_pk_mul_f32 v[100:101], v[40:41], v[88:89]
    v_pk_mul_f32 v[102:103], v[44:45], v[88:89]
    v_pk_fma_f32 v[96:97], v[34:35], v[90:91], v[96:97]
    v_pk_fma_f32 v[98:99], v[38:39], v[90:91], v[98:99]
    v_pk_fma_f32 v[100:101], v[42:43], v[90:91], v[100:101]
    v_pk_fma_f32 v[102:103], v[46:47], v[90:91], v[102:103]
    v_add_f32 v120, v96, v97
    v_add_f32 v121, v98, v99
    v_add_f32 v122, v100, v101
    v_add_f32 v123, v102, v103
    v_pk_mul_f32 v[96:97], v[32:33], v[92:93]
    v_pk_mul_f32 v[98:99], v[36:37], v[92:93]
    v_pk_mul_f32 v[100:101], v[40:41], v[92:93]
    v_pk_mul_f32 v[102:103], v[44:45], v[92:93]
    v_pk_fma_f32 v[96:97], v[34:35], v[94:95], v[96:97]
    v_pk_fma_f32 v[98:99], v[38:39], v[94:95], v[98:99]
    v_pk_fma_f32 v[100:101], v[42:43], v[94:95], v[100:101]
    v_pk_fma_f32 v[102:103], v[46:47], v[94:95], v[102:103]
    v_add_f32 v124, v96, v97
    v_add_f32 v125, v98, v99
    v_add_f32 v126, v100, v101
    v_add_f32 v127, v102, v103
    v_permlane32_swap_b32 v104, v106
    v_permlane32_swap_b32 v105, v107
    v_permlane32_swap_b32 v108, v110
    v_permlane32_swap_b32 v109, v111
    v_permlane32_swap_b32 v112, v114
    v_permlane32_swap_b32 v113, v115
    v_permlane32_swap_b32 v116, v118
    v_permlane32_swap_b32 v117, v119
    v_permlane32_swap_b32 v120, v122
    v_permlane32_swap_b32 v121, v123
    v_permlane32_swap_b32 v124, v126
    v_permlane32_swap_b32 v125, v127
    v_add_f32 v104, v104, v106
    v_add_f32 v105, v105, v107
    v_add_f32 v108, v108, v110
    v_add_f32 v109, v109, v111
    v_add_f32 v112, v112, v114
    v_add_f32 v113, v113, v115
    v_add_f32 v116, v116, v118
    v_add_f32 v117, v117, v119
    v_add_f32 v120, v120, v122
    v_add_f32 v121, v121, v123
    v_add_f32 v124, v124, v126
    v_add_f32 v125, v125, v127
    v_permlane16_swap_b32 v104, v105
    v_permlane16_swap_b32 v108, v109
    v_permlane16_swap_b32 v112, v113
    v_permlane16_swap_b32 v116, v117
    v_permlane16_swap_b32 v120, v121
    v_permlane16_swap_b32 v124, v125
    v_add_f32 v104, v104, v105
    v_add_f32 v108, v108, v109
    v_add_f32 v112, v112, v113
    v_add_f32 v116, v116, v117
    v_add_f32 v120, v120, v121
    v_add_f32 v124, v124, v125
    ds_write_b32 v12, v104 offset:0
    ds_write_b32 v12, v108 offset:1024
    ds_write_b32 v12, v112 offset:2048
    ds_write_b32 v12, v116 offset:3072
    ds_write_b32 v12, v120 offset:4096
    ds_write_b32 v12, v124 offset:5120
    s_lshl_b32 s64, s53, 2
    v_mov_b32 v24, s64
    s_add_u32 s92, s56, 3
    v_mov_b32 v25, s92
    v_and_b32 v27, 7, v0
    v_lshlrev_b32 v27, 2, v27
    s_waitcnt vmcnt(0) lgkmcnt(0)
    s_barrier
    s_setprio 2
    s_cmp_lg_u32 s52, 0
    s_cbranch_scc1 L_pub_1012n
    s_cmp_eq_u32 s57, 0
    s_cbranch_scc1 L_st_1013s
    buffer_store_dword v25, v24, s[40:43], s93 offen
L_st_1013e:
    s_branch L_pub_1012e
L_pub_1012n:
    s_cmp_lg_u32 s52, 1
    s_cbranch_scc1 L_pub_1012e
    v_add_u32 v28, 155648, v1
    ds_read_b128 v[96:99], v28 offset:0
    ds_read_b128 v[100:103], v28 offset:1024
    ds_read_b128 v[104:107], v28 offset:2048
    ds_read_b128 v[108:111], v28 offset:3072
    ds_read_b128 v[112:115], v28 offset:4096
    ds_read_b128 v[116:119], v28 offset:5120
    v_mov_b32 v19, s56
    v_mov_b32 v23, s56
    s_and_b32 s64, s53, 1
    s_lshl_b32 s64, s64, 13
    s_lshr_b32 s65, s53, 1
    s_lshl_b32 s65, s65, 4
    s_add_u32 s64, s64, s65
    s_add_u32 s64, s64, s58
    s_add_u32 s64, s64, 0x20000
    s_add_u32 s65, s64, 4096
    v_lshlrev_b32 v29, 6, v0
    s_waitcnt lgkmcnt(0)
    v_add_f32 v96, v96, v97
    v_add_f32 v98, v98, v99
    v_add_f32 v100, v100, v101
    v_add_f32 v102, v102, v103
    v_add_f32 v104, v104, v105
    v_add_f32 v106, v106, v107
    v_add_f32 v108, v108, v109
    v_add_f32 v110, v110, v111
    v_add_f32 v112, v112, v113
    v_add_f32 v114, v114, v115
    v_add_f32 v116, v116, v117
    v_add_f32 v118, v118, v119
    v_add_f32 v16, v96, v98
    v_add_f32 v17, v100, v102
    v_add_f32 v18, v104, v106
    v_add_f32 v20, v108, v110
    v_add_f32 v21, v112, v114
    v_add_f32 v22, v116, v118
    s_cmp_eq_u32 s57, 0
    s_cbranch_scc1 L_st_1014s
    buffer_store_dwordx4 v[16:19], v29, s[40:43], s64 offen
    buffer_store_dwordx4 v[20:23], v29, s[40:43], s65 offen
L_st_1014e:
L_pub_1012e:
    s_lshr_b32 s72, s62, 2
    s_add_u32 s72, s72, s58
    s_add_u32 s72, s72, 0x20000
    s_add_u32 s73, s72, 4096
    s_add_u32 s74, s72, 8192
    s_add_u32 s75, s72, 12288
    s_add_u32 s76, s72, 16384
    s_add_u32 s77, s72, 20480
    s_waitcnt lgkmcnt(0)
    s_cmp_lg_u32 s52, 0
    s_cbranch_scc1 L_pol_1015
    buffer_load_dword v26, v27, s[40:43], s93 offen sc1
    s_waitcnt vmcnt(0)
L_pl_1016c:
    v_subrev_u32 v26, s92, v26
    v_cmp_lt_u32 vcc, 7, v26
    s_cbranch_vccnz L_pl_1016r
L_pl_1016y:
L_pol_1015:
    s_barrier
    s_add_u32 m0, s62, 0
    s_nop 0
    buffer_load_dwordx4 v1, s[40:43], s80 offen offset:0 sc1 lds
    buffer_load_dwordx4 v1, s[40:43], s80 offen offset:1024 sc1 lds
    buffer_load_dwordx4 v1, s[40:43], s80 offen offset:2048 sc1 lds
    buffer_load_dwordx4 v1, s[40:43], s80 offen offset:3072 sc1 lds
    s_add_u32 m0, s62, 16384
    s_nop 0
    buffer_load_dwordx4 v1, s[40:43], s81 offen offset:0 sc1 lds
    buffer_load_dwordx4 v1, s[40:43], s81 offen offset:1024 sc1 lds
    s_waitcnt vmcnt(4)
    s_barrier
    buffer_load_dwordx4 v1, s[40:43], s81 offen offset:2048 sc1 lds
    buffer_load_dwordx4 v1, s[40:43], s81 offen offset:3072 sc1 lds
    s_waitcnt vmcnt(4)
    s_barrier
    buffer_load_dwordx4 v[128:131], v1, s[40:43], s72 offen sc1
    buffer_load_dwordx4 v[132:135], v1, s[40:43], s73 offen sc1
    buffer_load_dwordx4 v[136:139], v1, s[40:43], s74 offen sc1
    buffer_load_dwordx4 v[140:143], v1, s[40:43], s75 offen sc1
    s_add_u32 m0, s62, 32768
    s_nop 0
    buffer_load_dwordx4 v1, s[40:43], s82 offen offset:0 sc1 lds
    buffer_load_dwordx4 v1, s[40:43], s82 offen offset:1024 sc1 lds
    buffer_load_dwordx4 v1, s[40:43], s82 offen offset:2048 sc1 lds
    buffer_load_dwordx4 v1, s[40:43], s82 offen offset:3072 sc1 lds
    s_waitcnt vmcnt(8)
    s_barrier
    s_add_u32 m0, s62, 49152
    s_nop 0
    buffer_load_dwordx4 v1, s[40:43], s83 offen offset:0 sc1 lds
    buffer_load_dwordx4 v1, s[40:43], s83 offen offset:1024 sc1 lds
    buffer_load_dwordx4 v1, s[40:43], s83 offen offset:2048 sc1 lds
    buffer_load_dwordx4 v1, s[40:43], s83 offen offset:3072 sc1 lds
    s_waitcnt vmcnt(4)
    s_barrier
    s_mul_i32 s64, s52, 22016
    s_add_u32 s36, s20, s64
    s_addc_u32 s37, s21, 0
    s_sub_u32 s38, 1409024, s64
    s_add_u32 s64, s5, 4
    s_and_b32 s64, s64, 15
    s_mul_i32 s63, s64, 88064
    s_add_u32 m0, s61, 65536
    s_nop 0
    buffer_load_dwordx4 v72, s[36:39], s63 offen offset:0 lds
    buffer_load_dwordx4 v73, s[36:39], s63 offen offset:1024 lds
    buffer_load_dwordx4 v74, s[36:39], s63 offen offset:2048 lds
    s_add_u32 s63, s63, 88064
    s_cmp_ge_u32 s63, 1409024
    s_cselect_b32 s63, 0, s63
    s_add_u32 m0, s61, 77824
    s_nop 0
    buffer_load_dwordx4 v72, s[36:39], s63 offen offset:0 lds
    buffer_load_dwordx4 v73, s[36:39], s63 offen offset:1024 lds
    buffer_load_dwordx4 v74, s[36:39], s63 offen offset:2048 lds
    s_add_u32 s63, s63, 88064
    s_cmp_ge_u32 s63, 1409024
    s_cselect_b32 s63, 0, s63
    s_waitcnt vmcnt(6)
    s_barrier
    v_mov_b32 v144, 161856
    ds_read_b64 v[148:149], v144 offset:16
    ds_read_b128 v[144:147], v144
    s_waitcnt vmcnt(14)
L_pl_1017c:
    v_xor_b32 v96, s56, v131
    v_xor_b32 v97, s56, v135
    v_xor_b32 v98, s56, v139
    v_xor_b32 v99, s56, v143
    v_or3_b32 v96, v96, v97, v98
    v_or_b32 v96, v96, v99
    v_cmp_ne_u32 vcc, 0, v96
    s_cbranch_vccnz L_pl_1017r
L_pl_1017y:
    v_add_f32 v128, v128, v136
    v_add_f32 v129, v129, v137
    v_add_f32 v130, v130, v138
    v_add_f32 v132, v132, v140
    v_add_f32 v133, v133, v141
    v_add_f32 v134, v134, v142
    v_add_f32_dpp v128, v128, v128 quad_perm:[1,0,3,2] row_mask:0xf bank_mask:0xf
    v_add_f32_dpp v129, v129, v129 quad_perm:[1,0,3,2] row_mask:0xf bank_mask:0xf
    v_add_f32_dpp v130, v130, v130 quad_perm:[1,0,3,2] row_mask:0xf bank_mask:0xf
    v_add_f32_dpp v132, v132, v132 quad_perm:[1,0,3,2] row_mask:0xf bank_mask:0xf
    v_add_f32_dpp v133, v133, v133 quad_perm:[1,0,3,2] row_mask:0xf bank_mask:0xf
    v_add_f32_dpp v134, v134, v134 quad_perm:[1,0,3,2] row_mask:0xf bank_mask:0xf
    v_add_f32_dpp v128, v128, v128 quad_perm:[2,3,0,1] row_mask:0xf bank_mask:0xf
    v_add_f32_dpp v129, v129, v129 quad_perm:[2,3,0,1] row_mask:0xf bank_mask:0xf
    v_add_f32_dpp v130, v130, v130 quad_perm:[2,3,0,1] row_mask:0xf bank_mask:0xf
    v_add_f32_dpp v132, v132, v132 quad_perm:[2,3,0,1] row_mask:0xf bank_mask:0xf
    v_add_f32_dpp v133, v133, v133 quad_perm:[2,3,0,1] row_mask:0xf bank_mask:0xf
    v_add_f32_dpp v134, v134, v134 quad_perm:[2,3,0,1] row_mask:0xf bank_mask:0xf
    s_waitcnt lgkmcnt(0)
    v_mul_f32 v144, 0x3b000000, v144
    v_mul_f32 v146, 0x3b000000, v146
    v_mul_f32 v147, 0x3b000000, v147
    v_mul_f32 v148, 0x3b000000, v148
    v_mul_f32 v149, 0x3b000000, v149
    v_mul_f32 v128, 0x3b000000, v128
    v_mul_f32 v129, 0x3b000000, v129
    v_mul_f32 v130, 0x3b000000, v130
    v_mul_f32 v132, 0x3b000000, v132
    v_mul_f32 v133, 0x3b000000, v133
    v_mul_f32 v134, 0x3b000000, v134
    v_fma_f32 v96, -v128, v128, v129
    v_fma_f32 v130, -v128, v148, v130
    v_max_f32 v96, 0, v96
    v_fma_f32 v134, -v128, v146, v134
    v_add_f32 v96, 0x3727c5ac, v96
    v_mul_f32 v97, v144, v128
    v_rsq_f32 v96, v96
    v_fma_f32 v97, v133, -2.0, v97
    v_fma_f32 v132, v97, v128, v132
    v_fma_f32 v130, v130, v96, v149
    v_mul_f32 v132, v132, v96
    v_fma_f32 v132, v134, 2.0, v132
    v_fma_f32 v132, v132, v96, v147
    v_fma_f32 v132, -v130, v130, v132
    v_max_f32 v132, 0, v132
    v_add_f32 v132, 0x3727c5ac, v132
    v_rsq_f32 v102, v132
    v_mul_f32_e64 v97, -v128, v96
    v_mul_f32 v100, v102, v96
    v_mul_f32 v101, v102, v97
    v_mul_f32_e64 v103, -v102, v130
    v_lshrrev_b32 v105, 1, v2
    v_add_u32 v104, 150528, v2
    v_add_u32 v105, 151552, v105
    ds_write_b128 v104, v[100:103]
    ds_write_b64 v105, v[96:97]
    s_waitcnt lgkmcnt(0)
    s_barrier
    s_add_u32 m0, s61, 90112
    s_nop 0
    buffer_load_dwordx4 v72, s[36:39], s63 offen offset:0 lds
    buffer_load_dwordx4 v73, s[36:39], s63 offen offset:1024 lds
    buffer_load_dwordx4 v74, s[36:39], s63 offen offset:2048 lds
    s_add_u32 s63, s63, 88064
    s_cmp_ge_u32 s63, 1409024
    s_cselect_b32 s63, 0, s63
    s_waitcnt vmcnt(6)
    s_add_u32 m0, s61, 102400
    s_nop 0
    buffer_load_dwordx4 v72, s[36:39], s63 offen offset:0 lds
    buffer_load_dwordx4 v73, s[36:39], s63 offen offset:1024 lds
    buffer_load_dwordx4 v74, s[36:39], s63 offen offset:2048 lds
    s_add_u32 s63, s63, 88064
    s_cmp_ge_u32 s63, 1409024
    s_cselect_b32 s63, 0, s63
    s_waitcnt vmcnt(6)
    s_add_u32 m0, s61, 114688
    s_nop 0
    buffer_load_dwordx4 v72, s[36:39], s63 offen offset:0 lds
    buffer_load_dwordx4 v73, s[36:39], s63 offen offset:1024 lds
    buffer_load_dwordx4 v74, s[36:39], s63 offen offset:2048 lds
    s_add_u32 s63, s63, 88064
    s_cmp_ge_u32 s63, 1409024
    s_cselect_b32 s63, 0, s63
    s_waitcnt vmcnt(6)
    s_add_u32 m0, s61, 126976
    s_nop 0
    buffer_load_dwordx4 v72, s[36:39], s63 offen offset:0 lds
    buffer_load_dwordx4 v73, s[36:39], s63 offen offset:1024 lds
    buffer_load_dwordx4 v74, s[36:39], s63 offen offset:2048 lds
    s_add_u32 s63, s63, 88064
    s_cmp_ge_u32 s63, 1409024
    s_cselect_b32 s63, 0, s63
    s_setprio 0
    v_and_b32 v16, 15, v0
    v_lshlrev_b32 v16, 3, v16
    v_add_u32 v16, 151552, v16
    ds_read_b64 v[24:25], v16 offset:0
    ds_read_b64 v[26:27], v16 offset:128
    ds_read_b64 v[28:29], v16 offset:256
    ds_read_b64 v[30:31], v16 offset:384
    s_waitcnt lgkmcnt(0)
    s_lshl_b32 s14, s2, 2
    s_add_u32 s14, s14, s52
    s_mul_i32 s14, s14, 1408
    s_min_u32 s14, s14, 1407616
    s_add_u32 s14, s14, s22
    s_addc_u32 s15, s23, 0
    s_load_dword s35, s[14:15], 960
    s_load_dword s35, s[14:15], 1024
    s_load_dword s35, s[14:15], 1088
    s_load_dword s35, s[14:15], 1152
    s_load_dword s35, s[14:15], 1216
    s_load_dword s35, s[14:15], 1280
    s_load_dword s35, s[14:15], 1344
    v_fma_f32 v64, v48, v24, v25
    v_fma_f32 v65, v49, v24, v25
    v_fma_f32 v66, v50, v24, v25
    v_fma_f32 v67, v51, v24, v25
    v_fma_f32 v64, v64, v88, v92
    v_fma_f32 v65, v65, v89, v93
    v_fma_f32 v66, v66, v90, v94
    v_fma_f32 v67, v67, v91, v95
    v_fma_f32 v68, v52, v26, v27
    v_fma_f32 v69, v53, v26, v27
    v_fma_f32 v70, v54, v26, v27
    v_fma_f32 v71, v55, v26, v27
    v_fma_f32 v68, v68, v88, v92
    v_fma_f32 v69, v69, v89, v93
    v_fma_f32 v70, v70, v90, v94
    v_fma_f32 v71, v71, v91, v95
    v_fma_f32 v72, v56, v28, v29
    v_fma_f32 v73, v57, v28, v29
    v_fma_f32 v74, v58, v28, v29
    v_fma_f32 v75, v59, v28, v29
    v_fma_f32 v72, v72, v88, v92
    v_fma_f32 v73, v73, v89, v93
    v_fma_f32 v74, v74, v90, v94
    v_fma_f32 v75, v75, v91, v95
    v_fma_f32 v76, v60, v30, v31
    v_fma_f32 v77, v61, v30, v31
    v_fma_f32 v78, v62, v30, v31
    v_fma_f32 v79, v63, v30, v31
    v_fma_f32 v76, v76, v88, v92
    v_fma_f32 v77, v77, v89, v93
    v_fma_f32 v78, v78, v90, v94
    v_fma_f32 v79, v79, v91, v95
    s_branch L_pg_1018
.p2align 12
L_pg_1018:
    v_mov_b32 v3, v4
    v_add_u32 v4, 0x10000, v3
    v_add_u32 v13, 0x20000, v3
    s_add_u32 s70, s58, 0x10000
    s_add_u32 s71, s58, 0x18000
    s_lshr_b32 s80, s5, 2
    s_add_u32 s80, s52, s80
    s_and_b32 s80, s80, 3
    s_lshl_b32 s80, s80, 12
    s_add_u32 s80, s80, s70
    s_add_u32 s81, s80, 16384
    s_add_u32 s82, s80, 32768
    s_add_u32 s83, s80, 49152
    s_waitcnt vmcnt(0)
    s_barrier
    s_setprio 1
    s_waitcnt vmcnt(0)
    s_barrier
    s_waitcnt lgkmcnt(0)
    s_barrier
    ds_read_b128 v[16:19], v5 offset:256
    ds_read_b128 v[20:23], v5 offset:512
    ds_read_b128 v[24:27], v5 offset:768
    ds_read_b128 v[28:31], v5 offset:1280
    ds_read_b128 v[112:115], v5 offset:1536
    ds_read_b128 v[116:119], v5 offset:1792
    s_waitcnt lgkmcnt(4)
    v_mfma_f32_16x16x32_bf16 v[36:39], v[192:195], v[16:19], 0
    s_barrier
    ds_read_b128 v[120:123], v5 offset:2304
    ds_read_b128 v[124:127], v5 offset:2560
    ds_read_b128 v[16:19], v5 offset:2816
    v_mfma_f32_16x16x32_bf16 v[40:43], v[192:195], v[20:23], 0
    ds_read_b128 v[20:23], v5 offset:3328
    s_waitcnt lgkmcnt(6)
    v_mfma_f32_16x16x32_bf16 v[44:47], v[192:195], v[24:27], 0
    ds_read_b128 v[24:27], v5 offset:3584
    v_mfma_f32_16x16x32_bf16 v[36:39], v[196:199], v[28:31], v[36:39]
    ds_read_b128 v[28:31], v5 offset:3840
    s_waitcnt lgkmcnt(6)
    v_mfma_f32_16x16x32_bf16 v[40:43], v[196:199], v[112:115], v[40:43]
    s_barrier
    ds_read_b128 v[112:115], v5 offset:16384
    v_mfma_f32_16x16x32_bf16 v[44:47], v[196:199], v[116:119], v[44:47]
    ds_read_b128 v[116:119], v5 offset:16640
    s_waitcnt lgkmcnt(6)
    v_mfma_f32_16x16x32_bf16 v[36:39], v[200:203], v[120:123], v[36:39]
    ds_read_b128 v[120:123], v5 offset:16896
    v_mfma_f32_16x16x32_bf16 v[40:43], v[200:203], v[124:127], v[40:43]
    ds_read_b128 v[124:127], v5 offset:17152
    s_waitcnt lgkmcnt(6)
    v_mfma_f32_16x16x32_bf16 v[44:47], v[200:203], v[16:19], v[44:47]
    ds_read_b128 v[16:19], v5 offset:0
    v_mfma_f32_16x16x32_bf16 v[36:39], v[204:207], v[20:23], v[36:39]
    ds_read_b128 v[20:23], v5 offset:1024
    s_waitcnt lgkmcnt(6)
    v_mfma_f32_16x16x32_bf16 v[40:43], v[204:207], v[24:27], v[40:43]
    ds_read_b128 v[24:27], v5 offset:2048
    v_mfma_f32_16x16x32_bf16 v[44:47], v[204:207], v[28:31], v[44:47]
    ds_read_b128 v[28:31], v5 offset:3072
    s_waitcnt lgkmcnt(6)
    v_mfma_f32_16x16x32_bf16 v[32:35], v[208:211], v[112:115], 0
    ds_read_b128 v[112:115], v5 offset:17408
    v_mfma_f32_16x16x32_bf16 v[36:39], v[208:211], v[116:119], v[36:39]
    ds_read_b128 v[116:119], v5 offset:17664
    s_waitcnt lgkmcnt(6)
    v_mfma_f32_16x16x32_bf16 v[40:43], v[208:211], v[120:123], v[40:43]
    ds_read_b128 v[120:123], v5 offset:17920
    v_mfma_f32_16x16x32_bf16 v[44:47], v[208:211], v[124:127], v[44:47]
    ds_read_b128 v[124:127], v5 offset:18176
    s_waitcnt lgkmcnt(6)
    v_mfma_f32_16x16x32_bf16 v[32:35], v[192:195], v[16:19], v[32:35]
    ds_read_b128 v[16:19], v5 offset:18432
    v_mfma_f32_16x16x32_bf16 v[32:35], v[196:199], v[20:23], v[32:35]
    ds_read_b128 v[20:23], v5 offset:18688
    s_waitcnt lgkmcnt(6)
    v_mfma_f32_16x16x32_bf16 v[32:35], v[200:203], v[24:27], v[32:35]
    ds_read_b128 v[24:27], v5 offset:18944
    v_mfma_f32_16x16x32_bf16 v[32:35], v[204:207], v[28:31], v[32:35]
    ds_read_b128 v[28:31], v5 offset:19200
    s_waitcnt lgkmcnt(6)
    v_mfma_f32_16x16x32_bf16 v[32:35], v[212:215], v[112:115], v[32:35]
    ds_read_b128 v[112:115], v5 offset:19456
    v_mfma_f32_16x16x32_bf16 v[36:39], v[212:215], v[116:119], v[36:39]
    ds_read_b128 v[116:119], v5 offset:19712
    s_waitcnt lgkmcnt(6)
    v_mfma_f32_16x16x32_bf16 v[40:43], v[212:215], v[120:123], v[40:43]
    ds_read_b128 v[120:123], v5 offset:19968
    v_mfma_f32_16x16x32_bf16 v[44:47], v[212:215], v[124:127], v[44:47]
    ds_read_b128 v[124:127], v5 offset:20224
    s_waitcnt lgkmcnt(6)
    v_mfma_f32_16x16x32_bf16 v[32:35], v[216:219], v[16:19], v[32:35]
    s_barrier
    ds_read_b128 v[16:19], v5 offset:32768
    v_mfma_f32_16x16x32_bf16 v[36:39], v[216:219], v[20:23], v[36:39]
    ds_read_b128 v[20:23], v5 offset:33024
    s_waitcnt lgkmcnt(6)
    v_mfma_f32_16x16x32_bf16 v[40:43], v[216:219], v[24:27], v[40:43]
    ds_read_b128 v[24:27], v5 offset:33280
    v_mfma_f32_16x16x32_bf16 v[44:47], v[216:219], v[28:31], v[44:47]
    ds_read_b128 v[28:31], v5 offset:33536
    s_waitcnt lgkmcnt(6)
    v_mfma_f32_16x16x32_bf16 v[32:35], v[220:223], v[112:115], v[32:35]
    ds_read_b128 v[112:115], v5 offset:33792
    v_mfma_f32_16x16x32_bf16 v[36:39], v[220:223], v[116:119], v[36:39]
    ds_read_b128 v[116:119], v5 offset:34048
    s_waitcnt lgkmcnt(6)
    v_mfma_f32_16x16x32_bf16 v[40:43], v[220:223], v[120:123], v[40:43]
    ds_read_b128 v[120:123], v5 offset:34304
    v_mfma_f32_16x16x32_bf16 v[44:47], v[220:223], v[124:127], v[44:47]
    ds_read_b128 v[124:127], v5 offset:34560
    s_waitcnt lgkmcnt(6)
    v_mfma_f32_16x16x32_bf16 v[32:35], v[224:227], v[16:19], v[32:35]
    ds_read_b128 v[16:19], v5 offset:34816
    v_mfma_f32_16x16x32_bf16 v[36:39], v[224:227], v[20:23], v[36:39]
    ds_read_b128 v[20:23], v5 offset:35072
    s_waitcnt lgkmcnt(6)
    v_mfma_f32_16x16x32_bf16 v[40:43], v[224:227], v[24:27], v[40:43]
    ds_read_b128 v[24:27], v5 offset:35328
    v_mfma_f32_16x16x32_bf16 v[44:47], v[224:227], v[28:31], v[44:47]
    ds_read_b128 v[28:31], v5 offset:35584
    s_waitcnt lgkmcnt(6)
    v_mfma_f32_16x16x32_bf16 v[32:35], v[228:231], v[112:115], v[32:35]
    ds_read_b128 v[112:115], v5 offset:35840
    v_mfma_f32_16x16x32_bf16 v[36:39], v[228:231], v[116:119], v[36:39]
    ds_read_b128 v[116:119], v5 offset:36096
    s_waitcnt lgkmcnt(6)
    v_mfma_f32_16x16x32_bf16 v[40:43], v[228:231], v[120:123], v[40:43]
    ds_read_b128 v[120:123], v5 offset:36352
    v_mfma_f32_16x16x32_bf16 v[44:47], v[228:231], v[124:127], v[44:47]
    ds_read_b128 v[124:127], v5 offset:36608
    s_waitcnt lgkmcnt(6)
    v_mfma_f32_16x16x32_bf16 v[32:35], v[232:235], v[16:19], v[32:35]
    s_barrier
    ds_read_b128 v[16:19], v5 offset:49152
    v_mfma_f32_16x16x32_bf16 v[36:39], v[232:235], v[20:23], v[36:39]
    ds_read_b128 v[20:23], v5 offset:49408
    s_waitcnt lgkmcnt(6)
    v_mfma_f32_16x16x32_bf16 v[40:43], v[232:235], v[24:27], v[40:43]
    ds_read_b128 v[24:27], v5 offset:49664
    v_mfma_f32_16x16x32_bf16 v[44:47], v[232:235], v[28:31], v[44:47]
    ds_read_b128 v[28:31], v5 offset:49920
    s_waitcnt lgkmcnt(6)
    v_mfma_f32_16x16x32_bf16 v[32:35], v[236:239], v[112:115], v[32:35]
    ds_read_b128 v[112:115], v5 offset:50176
    v_mfma_f32_16x16x32_bf16 v[36:39], v[236:239], v[116:119], v[36:39]
    ds_read_b128 v[116:119], v5 offset:50432
    s_waitcnt lgkmcnt(6)
    v_mfma_f32_16x16x32_bf16 v[40:43], v[236:239], v[120:123], v[40:43]
    ds_read_b128 v[120:123], v5 offset:50688
    v_mfma_f32_16x16x32_bf16 v[44:47], v[236:239], v[124:127], v[44:47]
    ds_read_b128 v[124:127], v5 offset:50944
    s_waitcnt lgkmcnt(6)
    v_mfma_f32_16x16x32_bf16 v[32:35], v[240:243], v[16:19], v[32:35]
    ds_read_b128 v[16:19], v5 offset:51200
    v_mfma_f32_16x16x32_bf16 v[36:39], v[240:243], v[20:23], v[36:39]
    ds_read_b128 v[20:23], v5 offset:51456
    s_waitcnt lgkmcnt(6)
    v_mfma_f32_16x16x32_bf16 v[40:43], v[240:243], v[24:27], v[40:43]
    ds_read_b128 v[24:27], v5 offset:51712
    v_mfma_f32_16x16x32_bf16 v[44:47], v[240:243], v[28:31], v[44:47]
    ds_read_b128 v[28:31], v5 offset:51968
    s_waitcnt lgkmcnt(6)
    v_mfma_f32_16x16x32_bf16 v[32:35], v[244:247], v[112:115], v[32:35]
    ds_read_b128 v[112:115], v5 offset:52224
    v_mfma_f32_16x16x32_bf16 v[36:39], v[244:247], v[116:119], v[36:39]
    ds_read_b128 v[116:119], v5 offset:52480
    s_waitcnt lgkmcnt(6)
    v_mfma_f32_16x16x32_bf16 v[40:43], v[244:247], v[120:123], v[40:43]
    ds_read_b128 v[120:123], v5 offset:52736
    v_mfma_f32_16x16x32_bf16 v[44:47], v[244:247], v[124:127], v[44:47]
    ds_read_b128 v[124:127], v5 offset:52992
    s_waitcnt lgkmcnt(6)
    v_mfma_f32_16x16x32_bf16 v[32:35], v[248:251], v[16:19], v[32:35]
    v_mfma_f32_16x16x32_bf16 v[36:39], v[248:251], v[20:23], v[36:39]
    s_waitcnt lgkmcnt(4)
    v_mfma_f32_16x16x32_bf16 v[40:43], v[248:251], v[24:27], v[40:43]
    v_mfma_f32_16x16x32_bf16 v[44:47], v[248:251], v[28:31], v[44:47]
    s_waitcnt lgkmcnt(2)
    v_mfma_f32_16x16x32_bf16 v[32:35], v[252:255], v[112:115], v[32:35]
    v_mfma_f32_16x16x32_bf16 v[36:39], v[252:255], v[116:119], v[36:39]
    s_waitcnt lgkmcnt(0)
    v_mfma_f32_16x16x32_bf16 v[40:43], v[252:255], v[120:123], v[40:43]
    v_mfma_f32_16x16x32_bf16 v[44:47], v[252:255], v[124:127], v[44:47]
    s_setprio 3
    s_nop 2
    v_pk_add_f32 v[64:65], v[64:65], v[32:33]
    v_pk_add_f32 v[66:67], v[66:67], v[34:35]
    v_pk_add_f32 v[68:69], v[68:69], v[36:37]
    v_pk_add_f32 v[70:71], v[70:71], v[38:39]
    v_pk_add_f32 v[72:73], v[72:73], v[40:41]
    v_pk_add_f32 v[74:75], v[74:75], v[42:43]
    v_pk_add_f32 v[76:77], v[76:77], v[44:45]
    v_pk_add_f32 v[78:79], v[78:79], v[46:47]
    v_cvt_pk_bf16_f32 v16, v64, v65
    v_cvt_pk_bf16_f32 v17, v66, v67
    v_cvt_pk_bf16_f32 v18, v68, v69
    v_cvt_pk_bf16_f32 v19, v70, v71
    v_cvt_pk_bf16_f32 v20, v72, v73
    v_cvt_pk_bf16_f32 v21, v74, v75
    v_cvt_pk_bf16_f32 v22, v76, v77
    v_cvt_pk_bf16_f32 v23, v78, v79
    v_permlane16_swap_b32 v16, v18
    v_permlane16_swap_b32 v17, v19
    v_permlane16_swap_b32 v20, v22
    v_permlane16_swap_b32 v21, v23
    s_cmp_eq_u32 s57, 0
    s_cbranch_scc1 L_st_1019s
    buffer_store_dwordx4 v[16:19], v7, s[40:43], s70 offen
    buffer_store_dwordx4 v[20:23], v7, s[40:43], s71 offen
L_st_1019e:
    v_pk_add_f32 v[96:97], v[64:65], v[66:67]
    v_pk_add_f32 v[98:99], v[68:69], v[70:71]
    v_pk_add_f32 v[100:101], v[72:73], v[74:75]
    v_pk_add_f32 v[102:103], v[76:77], v[78:79]
    v_add_f32 v104, v96, v97
    v_add_f32 v105, v98, v99
    v_add_f32 v106, v100, v101
    v_add_f32 v107, v102, v103
    v_pk_mul_f32 v[96:97], v[64:65], v[64:65]
    v_pk_mul_f32 v[98:99], v[68:69], v[68:69]
    v_pk_mul_f32 v[100:101], v[72:73], v[72:73]
    v_pk_mul_f32 v[102:103], v[76:77], v[76:77]
    v_pk_fma_f32 v[96:97], v[66:67], v[66:67], v[96:97]
    v_pk_fma_f32 v[98:99], v[70:71], v[70:71], v[98:99]
    v_pk_fma_f32 v[100:101], v[74:75], v[74:75], v[100:101]
    v_pk_fma_f32 v[102:103], v[78:79], v[78:79], v[102:103]
    v_add_f32 v108, v96, v97
    v_add_f32 v109, v98, v99
    v_add_f32 v110, v100, v101
    v_add_f32 v111, v102, v103
    v_permlane32_swap_b32 v104, v106
    v_permlane32_swap_b32 v105, v107
    v_permlane32_swap_b32 v108, v110
    v_permlane32_swap_b32 v109, v111
    v_add_f32 v104, v104, v106
    v_add_f32 v105, v105, v107
    v_add_f32 v108, v108, v110
    v_add_f32 v109, v109, v111
    v_permlane16_swap_b32 v104, v105
    s_nop 0
    v_permlane16_swap_b32 v108, v109
    v_add_f32 v104, v104, v105
    v_add_f32 v108, v108, v109
    ds_write_b32 v12, v104 offset:0
    ds_write_b32 v12, v108 offset:1024
    s_lshl_b32 s64, s53, 2
    v_mov_b32 v24, s64
    s_add_u32 s92, s56, 5
    v_mov_b32 v25, s92
    v_and_b32 v27, 7, v0
    v_lshlrev_b32 v27, 2, v27
    s_waitcnt vmcnt(0) lgkmcnt(0)
    s_barrier
    s_setprio 2
    s_cmp_lg_u32 s52, 0
    s_cbranch_scc1 L_pub_1020n
    s_cmp_eq_u32 s57, 0
    s_cbranch_scc1 L_st_1021s
    buffer_store_dword v25, v24, s[40:43], s93 offen
L_st_1021e:
    s_branch L_pub_1020e
L_pub_1020n:
    s_cmp_lg_u32 s52, 1
    s_cbranch_scc1 L_pub_1020e
    v_add_u32 v28, 155648, v1
    ds_read_b128 v[96:99], v28 offset:0
    ds_read_b128 v[100:103], v28 offset:1024
    v_mov_b32 v19, s56
    v_mov_b32 v23, s56
    s_and_b32 s64, s53, 1
    s_lshl_b32 s64, s64, 12
    s_lshr_b32 s65, s53, 1
    s_lshl_b32 s65, s65, 4
    s_add_u32 s64, s64, s65
    s_add_u32 s64, s64, s58
    s_add_u32 s64, s64, 0x24000
    s_add_u32 s65, s64, 4096
    v_lshlrev_b32 v29, 6, v0
    s_waitcnt lgkmcnt(0)
    v_add_f32 v96, v96, v97
    v_add_f32 v98, v98, v99
    v_add_f32 v100, v100, v101
    v_add_f32 v102, v102, v103
    v_add_f32 v16, v96, v98
    v_add_f32 v17, v100, v102
    s_cmp_eq_u32 s57, 0
    s_cbranch_scc1 L_st_1022s
    buffer_store_dwordx4 v[16:19], v29, s[40:43], s64 offen
L_st_1022e:
L_pub_1020e:
    s_mov_b32 s36, s22
    s_mov_b32 s37, s23
    s_mov_b32 s38, 0x158000
    s_mov_b32 s39, 0x20000
    s_add_u32 s63, s6, s52
    s_cmp_ge_u32 s63, 43
    s_cselect_b32 s64, 43, 0
    s_sub_u32 s63, s63, s64
    s_lshl_b32 s63, s63, 15
    s_add_u32 s70, s58, 0x24000
    v_fma_f32 v48, v64, v80, v48
    v_fma_f32 v49, v65, v81, v49
    v_fma_f32 v50, v66, v82, v50
    v_fma_f32 v51, v67, v83, v51
    v_fma_f32 v52, v68, v80, v52
    v_fma_f32 v53, v69, v81, v53
    v_fma_f32 v54, v70, v82, v54
    v_fma_f32 v55, v71, v83, v55
    v_fma_f32 v56, v72, v80, v56
    v_fma_f32 v57, v73, v81, v57
    v_fma_f32 v58, v74, v82, v58
    v_fma_f32 v59, v75, v83, v59
    v_fma_f32 v60, v76, v80, v60
    v_fma_f32 v61, v77, v81, v61
    v_fma_f32 v62, v78, v82, v62
    v_fma_f32 v63, v79, v83, v63
    s_cmp_lg_u32 s52, 0
    s_cbranch_scc1 L_pol_1023
    buffer_load_dword v26, v27, s[40:43], s93 offen sc1
    s_waitcnt vmcnt(0)
L_pl_1024c:
    v_subrev_u32 v26, s92, v26
    v_cmp_lt_u32 vcc, 7, v26
    s_cbranch_vccnz L_pl_1024r
L_pl_1024y:
L_pol_1023:
    s_barrier
    s_add_u32 m0, s62, 0
    s_nop 0
    buffer_load_dwordx4 v1, s[40:43], s80 offen offset:0 sc1 lds
    buffer_load_dwordx4 v1, s[40:43], s80 offen offset:1024 sc1 lds
    buffer_load_dwordx4 v1, s[40:43], s80 offen offset:2048 sc1 lds
    buffer_load_dwordx4 v1, s[40:43], s80 offen offset:3072 sc1 lds
    s_add_u32 m0, s62, 16384
    s_nop 0
    buffer_load_dwordx4 v1, s[40:43], s81 offen offset:0 sc1 lds
    buffer_load_dwordx4 v1, s[40:43], s81 offen offset:1024 sc1 lds
    buffer_load_dwordx4 v1, s[40:43], s81 offen offset:2048 sc1 lds
    buffer_load_dwordx4 v1, s[40:43], s81 offen offset:3072 sc1 lds
    s_add_u32 s92, s56, 6
    v_mov_b32 v25, s92
    s_waitcnt vmcnt(4)
    s_barrier
    buffer_load_dwordx4 v[64:67], v1, s[40:43], s76 offen sc1
    buffer_load_dwordx4 v[68:71], v1, s[40:43], s77 offen sc1
    s_add_u32 m0, s62, 32768
    s_nop 0
    buffer_load_dwordx4 v1, s[40:43], s82 offen offset:0 sc1 lds
    buffer_load_dwordx4 v1, s[40:43], s82 offen offset:1024 sc1 lds
    buffer_load_dwordx4 v1, s[40:43], s82 offen offset:2048 sc1 lds
    buffer_load_dwordx4 v1, s[40:43], s82 offen offset:3072 sc1 lds
    s_add_u32 m0, s62, 49152
    s_nop 0
    buffer_load_dwordx4 v1, s[40:43], s83 offen offset:0 sc1 lds
    buffer_load_dwordx4 v1, s[40:43], s83 offen offset:1024 sc1 lds
    buffer_load_dwordx4 v1, s[40:43], s83 offen offset:2048 sc1 lds
    buffer_load_dwordx4 v1, s[40:43], s83 offen offset:3072 sc1 lds
    s_waitcnt vmcnt(8)
L_pl_1025c:
    v_xor_b32 v16, s56, v67
    v_xor_b32 v17, s56, v71
    v_or_b32 v16, v16, v17
    v_cmp_ne_u32 vcc, 0, v16
    s_cbranch_vccnz L_pl_1025r
L_pl_1025y:
    v_add_f32 v64, v64, v68
    v_add_f32 v65, v65, v69
    s_nop 0
    v_add_f32_dpp v64, v64, v64 quad_perm:[1,0,3,2] row_mask:0xf bank_mask:0xf
    v_add_f32_dpp v65, v65, v65 quad_perm:[1,0,3,2] row_mask:0xf bank_mask:0xf
    s_nop 0
    v_add_f32_dpp v64, v64, v64 quad_perm:[2,3,0,1] row_mask:0xf bank_mask:0xf
    v_add_f32_dpp v65, v65, v65 quad_perm:[2,3,0,1] row_mask:0xf bank_mask:0xf
    v_mul_f32 v16, 0xbb000000, v64
    v_mul_f32 v65, 0x3b000000, v65
    v_fma_f32 v65, -v16, v16, v65
    v_max_f32 v65, 0, v65
    v_add_f32 v65, 0x3727c5ac, v65
    v_rsq_f32 v64, v65
    v_sqrt_f32 v19, v65
    v_mul_f32 v17, 0xc0135761, v64
    v_mul_f32 v18, v64, v64
    v_mul_f32 v18, v18, v64
    v_mul_f32 v18, 0xbdd2d3e8, v18
    v_add_u32 v20, 152064, v2
    ds_write_b128 v20, v[16:19]
    s_add_u32 m0, s62, 65536
    s_nop 0
    buffer_load_dwordx4 v8, s[36:39], s63 offen offset:0 lds
    buffer_load_dwordx4 v9, s[36:39], s63 offen offset:1024 lds
    buffer_load_dwordx4 v10, s[36:39], s63 offen offset:2048 lds
    buffer_load_dwordx4 v11, s[36:39], s63 offen offset:3072 lds
    s_add_u32 s63, s63, 0x20000
    s_cmp_ge_u32 s63, 1409024
    s_cselect_b32 s64, 1409024, 0
    s_sub_u32 s63, s63, s64
    s_waitcnt vmcnt(4)
    s_waitcnt lgkmcnt(0)
    s_barrier
    s_cmp_lg_u32 s52, 0
    s_cbranch_scc1 L_xl_1026
    s_cmp_eq_u32 s57, 0
    s_cbranch_scc1 L_st_1027s
    buffer_store_dword v25, v24, s[40:43], s93 offen
L_st_1027e:
L_xl_1026:
    s_mov_b32 s44, s22
    s_mov_b32 s45, s23
    s_mov_b32 s46, 0x158000
    s_mov_b32 s47, 0x20000
    s_lshr_b32 s71, s2, 3
    s_lshl_b32 s71, s71, 2
    s_add_u32 s71, s71, s52
    s_mul_i32 s71, s71, 11264
    v_min_u32 v44, 10, v0
    v_lshlrev_b32 v44, 10, v44
    buffer_load_dword v45, v44, s[44:47], s71 offen offset:384
    s_mul_i32 s71, s90, 384
    s_add_u32 s71, s71, s58
    s_add_u32 s71, s71, 0x26000
    v_min_u32 v44, 5, v0
    v_lshlrev_b32 v44, 7, v44
    buffer_load_dword v45, v44, s[40:43], s71 offen sc1
    s_add_u32 m0, s62, 81920
    s_nop 0
    buffer_load_dwordx4 v8, s[36:39], s63 offen offset:0 lds
    buffer_load_dwordx4 v9, s[36:39], s63 offen offset:1024 lds
    buffer_load_dwordx4 v10, s[36:39], s63 offen offset:2048 lds
    buffer_load_dwordx4 v11, s[36:39], s63 offen offset:3072 lds
    s_add_u32 s63, s63, 0x20000
    s_cmp_ge_u32 s63, 1409024
    s_cselect_b32 s64, 1409024, 0
    s_sub_u32 s63, s63, s64
    s_add_u32 m0, s62, 98304
    s_nop 0
    buffer_load_dwordx4 v8, s[36:39], s63 offen offset:0 lds
    buffer_load_dwordx4 v9, s[36:39], s63 offen offset:1024 lds
    buffer_load_dwordx4 v10, s[36:39], s63 offen offset:2048 lds
    buffer_load_dwordx4 v11, s[36:39], s63 offen offset:3072 lds
    s_add_u32 s63, s63, 0x20000
    s_cmp_ge_u32 s63, 1409024
    s_cselect_b32 s64, 1409024, 0
    s_sub_u32 s63, s63, s64
    buffer_load_dword v26, v27, s[40:43], s93 offen sc1
    s_getpc_b64 s[48:49]
L_ct_1028:
    s_sub_u32 s48, s48, L_ct_1028-L_pc
    s_subb_u32 s49, s49, 0
    s_mov_b32 s50, L_codeend-L_pc
    s_mov_b32 s51, 0x20000
    s_lshr_b32 s95, s2, 3
    s_lshl_b32 s95, s95, 2
    s_add_u32 s95, s95, s52
    s_lshl_b32 s95, s95, 9
    v_min_u32 v28, 3, v0
    v_lshlrev_b32 v28, 7, v28
    buffer_load_dword v29, v28, s[48:51], s95 offen
    s_mov_b32 s44, s28
    s_mov_b32 s45, s29
    s_mov_b32 s46, 0x200000
    s_mov_b32 s47, 0x20000
    v_add_u32 v6, 0x10000, v5
    v_add_u32 v7, 0x20000, v5
    v_and_b32 v2, 31, v0
    s_lshl_b32 s65, s54, 6
    v_add_u32 v2, s65, v2
    v_lshlrev_b32 v2, 10, v2
    v_lshrrev_b32 v12, 5, v0
    v_add_u32 v12, s90, v12
    v_lshl_add_u32 v2, v12, 4, v2
    s_mov_b32 s71, 0x8000
    s_add_u32 m0, s62, 114688
    s_nop 0
    buffer_load_dwordx4 v8, s[36:39], s63 offen offset:0 lds
    buffer_load_dwordx4 v9, s[36:39], s63 offen offset:1024 lds
    buffer_load_dwordx4 v10, s[36:39], s63 offen offset:2048 lds
    buffer_load_dwordx4 v11, s[36:39], s63 offen offset:3072 lds
    s_add_u32 s63, s63, 0x20000
    s_cmp_ge_u32 s63, 1409024
    s_cselect_b32 s64, 1409024, 0
    s_sub_u32 s63, s63, s64
    s_waitcnt vmcnt(16)
    s_waitcnt lgkmcnt(0)
    s_barrier
    s_add_u32 m0, s62, 131072
    s_nop 0
    buffer_load_dwordx4 v8, s[36:39], s63 offen offset:0 lds
    buffer_load_dwordx4 v9, s[36:39], s63 offen offset:1024 lds
    buffer_load_dwordx4 v10, s[36:39], s63 offen offset:2048 lds
    buffer_load_dwordx4 v11, s[36:39], s63 offen offset:3072 lds
    s_add_u32 s63, s63, 0x20000
    s_cmp_ge_u32 s63, 1409024
    s_cselect_b32 s64, 1409024, 0
    s_sub_u32 s63, s63, s64
    ds_read_b64_tr_b16 v[84:85], v4 offset:0
    ds_read_b64_tr_b16 v[86:87], v4 offset:512
    ds_read_b64_tr_b16 v[88:89], v4 offset:4096
    ds_read_b64_tr_b16 v[90:91], v4 offset:4608
    ds_read_b64_tr_b16 v[92:93], v4 offset:8192
    ds_read_b64_tr_b16 v[94:95], v4 offset:8704
    ds_read_b64_tr_b16 v[96:97], v4 offset:12288
    ds_read_b64_tr_b16 v[98:99], v4 offset:12800
    s_add_u32 m0, s62, 0
    s_nop 0
    buffer_load_dwordx4 v8, s[36:39], s63 offen offset:0 lds
    buffer_load_dwordx4 v9, s[36:39], s63 offen offset:1024 lds
    buffer_load_dwordx4 v10, s[36:39], s63 offen offset:2048 lds
    buffer_load_dwordx4 v11, s[36:39], s63 offen offset:3072 lds
    s_add_u32 s63, s63, 0x20000
    s_cmp_ge_u32 s63, 1409024
    s_cselect_b32 s64, 1409024, 0
    s_sub_u32 s63, s63, s64
    s_waitcnt vmcnt(13)
L_pl_1029c:
    v_subrev_u32 v26, s92, v26
    v_cmp_lt_u32 vcc, 7, v26
    s_cbranch_vccnz L_pl_1029r
L_pl_1029y:
    s_waitcnt lgkmcnt(0)
    s_barrier
    s_add_u32 m0, s62, 16384
    s_nop 0
    buffer_load_dwordx4 v8, s[36:39], s63 offen offset:0 lds
    buffer_load_dwordx4 v9, s[36:39], s63 offen offset:1024 lds
    buffer_load_dwordx4 v10, s[36:39], s63 offen offset:2048 lds
    buffer_load_dwordx4 v11, s[36:39], s63 offen offset:3072 lds
    s_add_u32 s63, s63, 0x20000
    s_cmp_ge_u32 s63, 1409024
    s_cselect_b32 s64, 1409024, 0
    s_sub_u32 s63, s63, s64
    ds_read_b64_tr_b16 v[100:101], v4 offset:16384
    ds_read_b64_tr_b16 v[102:103], v4 offset:16896
    ds_read_b64_tr_b16 v[104:105], v4 offset:20480
    ds_read_b64_tr_b16 v[106:107], v4 offset:20992
    ds_read_b64_tr_b16 v[108:109], v4 offset:24576
    ds_read_b64_tr_b16 v[110:111], v4 offset:25088
    ds_read_b64_tr_b16 v[112:113], v4 offset:28672
    ds_read_b64_tr_b16 v[114:115], v4 offset:29184
    s_add_u32 m0, s62, 65536
    s_nop 0
    buffer_load_dwordx4 v8, s[36:39], s63 offen offset:0 lds
    buffer_load_dwordx4 v9, s[36:39], s63 offen offset:1024 lds
    buffer_load_dwordx4 v10, s[36:39], s63 offen offset:2048 lds
    buffer_load_dwordx4 v11, s[36:39], s63 offen offset:3072 lds
    s_add_u32 s63, s63, 0x20000
    s_cmp_ge_u32 s63, 1409024
    s_cselect_b32 s64, 1409024, 0
    s_sub_u32 s63, s63, s64
    ds_read_b64_tr_b16 v[116:117], v4 offset:32768
    ds_read_b64_tr_b16 v[118:119], v4 offset:33280
    ds_read_b64_tr_b16 v[120:121], v4 offset:36864
    ds_read_b64_tr_b16 v[122:123], v4 offset:37376
    ds_read_b64_tr_b16 v[124:125], v4 offset:40960
    ds_read_b64_tr_b16 v[126:127], v4 offset:41472
    ds_read_b64_tr_b16 v[128:129], v4 offset:45056
    ds_read_b64_tr_b16 v[130:131], v4 offset:45568
    s_waitcnt vmcnt(12)
    s_waitcnt lgkmcnt(0)
    s_barrier
    s_add_u32 m0, s62, 81920
    s_nop 0
    buffer_load_dwordx4 v8, s[36:39], s63 offen offset:0 lds
    buffer_load_dwordx4 v9, s[36:39], s63 offen offset:1024 lds
    buffer_load_dwordx4 v10, s[36:39], s63 offen offset:2048 lds
    buffer_load_dwordx4 v11, s[36:39], s63 offen offset:3072 lds
    s_add_u32 s63, s63, 0x20000
    s_cmp_ge_u32 s63, 1409024
    s_cselect_b32 s64, 1409024, 0
    s_sub_u32 s63, s63, s64
    ds_read_b64_tr_b16 v[132:133], v4 offset:49152
    ds_read_b64_tr_b16 v[134:135], v4 offset:49664
    ds_read_b64_tr_b16 v[136:137], v4 offset:53248
    ds_read_b64_tr_b16 v[138:139], v4 offset:53760
    ds_read_b64_tr_b16 v[140:141], v4 offset:57344
    ds_read_b64_tr_b16 v[142:143], v4 offset:57856
    ds_read_b64_tr_b16 v[144:145], v4 offset:61440
    ds_read_b64_tr_b16 v[146:147], v4 offset:61952
    s_add_u32 m0, s62, 98304
    s_nop 0
    buffer_load_dwordx4 v8, s[36:39], s63 offen offset:0 lds
    buffer_load_dwordx4 v9, s[36:39], s63 offen offset:1024 lds
    buffer_load_dwordx4 v10, s[36:39], s63 offen offset:2048 lds
    buffer_load_dwordx4 v11, s[36:39], s63 offen offset:3072 lds
    s_add_u32 s63, s63, 0x20000
    s_cmp_ge_u32 s63, 1409024
    s_cselect_b32 s64, 1409024, 0
    s_sub_u32 s63, s63, s64
    ds_read_b64_tr_b16 v[148:149], v13 offset:0
    ds_read_b64_tr_b16 v[150:151], v13 offset:512
    ds_read_b64_tr_b16 v[152:153], v13 offset:4096
    ds_read_b64_tr_b16 v[154:155], v13 offset:4608
    ds_read_b64_tr_b16 v[156:157], v13 offset:8192
    ds_read_b64_tr_b16 v[158:159], v13 offset:8704
    ds_read_b64_tr_b16 v[160:161], v13 offset:12288
    ds_read_b64_tr_b16 v[162:163], v13 offset:12800
    s_waitcnt vmcnt(16)
    s_waitcnt lgkmcnt(0)
    s_barrier
    s_add_u32 m0, s62, 32768
    s_nop 0
    buffer_load_dwordx4 v8, s[36:39], s63 offen offset:0 lds
    buffer_load_dwordx4 v9, s[36:39], s63 offen offset:1024 lds
    buffer_load_dwordx4 v10, s[36:39], s63 offen offset:2048 lds
    buffer_load_dwordx4 v11, s[36:39], s63 offen offset:3072 lds
    s_add_u32 s63, s63, 0x20000
    s_cmp_ge_u32 s63, 1409024
    s_cselect_b32 s64, 1409024, 0
    s_sub_u32 s63, s63, s64
    ds_read_b64_tr_b16 v[164:165], v3 offset:0
    ds_read_b64_tr_b16 v[166:167], v3 offset:512
    ds_read_b64_tr_b16 v[168:169], v3 offset:4096
    ds_read_b64_tr_b16 v[170:171], v3 offset:4608
    ds_read_b64_tr_b16 v[172:173], v3 offset:8192
    ds_read_b64_tr_b16 v[174:175], v3 offset:8704
    ds_read_b64_tr_b16 v[176:177], v3 offset:12288
    ds_read_b64_tr_b16 v[178:179], v3 offset:12800
    s_waitcnt vmcnt(12)
    s_waitcnt lgkmcnt(0)
    s_barrier
    ds_read_b64_tr_b16 v[180:181], v3 offset:16384
    ds_read_b64_tr_b16 v[182:183], v3 offset:16896
    ds_read_b64_tr_b16 v[184:185], v3 offset:20480
    ds_read_b64_tr_b16 v[186:187], v3 offset:20992
    ds_read_b64_tr_b16 v[188:189], v3 offset:24576
    ds_read_b64_tr_b16 v[190:191], v3 offset:25088
    ds_read_b64_tr_b16 v[192:193], v3 offset:28672
    ds_read_b64_tr_b16 v[194:195], v3 offset:29184
    ds_read_b64_tr_b16 v[196:197], v4 offset:0
    ds_read_b64_tr_b16 v[198:199], v4 offset:512
    ds_read_b64_tr_b16 v[200:201], v4 offset:4096
    ds_read_b64_tr_b16 v[202:203], v4 offset:4608
    ds_read_b64_tr_b16 v[204:205], v4 offset:8192
    ds_read_b64_tr_b16 v[206:207], v4 offset:8704
    ds_read_b64_tr_b16 v[208:209], v4 offset:12288
    ds_read_b64_tr_b16 v[210:211], v4 offset:12800
    s_waitcnt vmcnt(0)
    s_branch L_pg_1030
.p2align 12
L_pg_1030:
    s_barrier
    ds_read_b64_tr_b16 v[212:213], v4 offset:16384
    ds_read_b64_tr_b16 v[214:215], v4 offset:16896
    ds_read_b64_tr_b16 v[216:217], v4 offset:20480
    ds_read_b64_tr_b16 v[218:219], v4 offset:20992
    ds_read_b64_tr_b16 v[220:221], v4 offset:24576
    ds_read_b64_tr_b16 v[222:223], v4 offset:25088
    ds_read_b64_tr_b16 v[224:225], v4 offset:28672
    ds_read_b64_tr_b16 v[226:227], v4 offset:29184
    ds_read_b64_tr_b16 v[228:229], v4 offset:32768
    ds_read_b64_tr_b16 v[230:231], v4 offset:33280
    ds_read_b64_tr_b16 v[232:233], v4 offset:36864
    ds_read_b64_tr_b16 v[234:235], v4 offset:37376
    ds_read_b64_tr_b16 v[236:237], v4 offset:40960
    ds_read_b64_tr_b16 v[238:239], v4 offset:41472
    ds_read_b64_tr_b16 v[240:241], v4 offset:45056
    ds_read_b64_tr_b16 v[242:243], v4 offset:45568
    ds_read_b64_tr_b16 v[244:245], v3 offset:32768
    ds_read_b64_tr_b16 v[246:247], v3 offset:33280
    ds_read_b64_tr_b16 v[248:249], v3 offset:36864
    ds_read_b64_tr_b16 v[250:251], v3 offset:37376
    ds_read_b64_tr_b16 v[252:253], v3 offset:40960
    ds_read_b64_tr_b16 v[254:255], v3 offset:41472
    s_waitcnt lgkmcnt(0)
    s_setprio 1
    s_barrier
    s_barrier
    ds_read_b128 v[16:19], v5 offset:0
    ds_read_b128 v[20:23], v5 offset:256
    ds_read_b128 v[24:27], v5 offset:512
    ds_read_b128 v[28:31], v5 offset:768
    ds_read_b128 v[64:67], v5 offset:1024
    ds_read_b128 v[68:71], v5 offset:1280
    ds_read_b128 v[72:75], v5 offset:1536
    ds_read_b128 v[76:79], v5 offset:1792
    s_waitcnt lgkmcnt(6)
    v_mfma_f32_16x16x32_bf16 v[32:35], v[84:87], v[16:19], 0
    ds_read_b128 v[16:19], v5 offset:2048
    v_mfma_f32_16x16x32_bf16 v[36:39], v[84:87], v[20:23], 0
    ds_read_b128 v[20:23], v5 offset:2304
    s_waitcnt lgkmcnt(6)
    v_mfma_f32_16x16x32_bf16 v[40:43], v[84:87], v[24:27], 0
    ds_read_b128 v[24:27], v5 offset:2560
    v_mfma_f32_16x16x32_bf16 v[44:47], v[84:87], v[28:31], 0
    ds_read_b128 v[28:31], v5 offset:2816
    s_waitcnt lgkmcnt(6)
    v_mfma_f32_16x16x32_bf16 v[32:35], v[88:91], v[64:67], v[32:35]
    ds_read_b128 v[64:67], v5 offset:3072
    v_mfma_f32_16x16x32_bf16 v[36:39], v[88:91], v[68:71], v[36:39]
    ds_read_b128 v[68:71], v5 offset:3328
    s_waitcnt lgkmcnt(6)
    v_mfma_f32_16x16x32_bf16 v[40:43], v[88:91], v[72:75], v[40:43]
    ds_read_b128 v[72:75], v5 offset:3584
    v_mfma_f32_16x16x32_bf16 v[44:47], v[88:91], v[76:79], v[44:47]
    ds_read_b128 v[76:79], v5 offset:3840
    s_waitcnt lgkmcnt(6)
    v_mfma_f32_16x16x32_bf16 v[32:35], v[92:95], v[16:19], v[32:35]
    s_barrier
    ds_read_b128 v[16:19], v5 offset:16384
    v_mfma_f32_16x16x32_bf16 v[36:39], v[92:95], v[20:23], v[36:39]
    ds_read_b128 v[20:23], v5 offset:16640
    s_waitcnt lgkmcnt(6)
    v_mfma_f32_16x16x32_bf16 v[40:43], v[92:95], v[24:27], v[40:43]
    ds_read_b128 v[24:27], v5 offset:16896
    v_mfma_f32_16x16x32_bf16 v[44:47], v[92:95], v[28:31], v[44:47]
    ds_read_b128 v[28:31], v5 offset:17152
    s_waitcnt lgkmcnt(6)
    v_mfma_f32_16x16x32_bf16 v[32:35], v[96:99], v[64:67], v[32:35]
    ds_read_b128 v[64:67], v5 offset:17408
    v_mfma_f32_16x16x32_bf16 v[36:39], v[96:99], v[68:71], v[36:39]
    ds_read_b128 v[68:71], v5 offset:17664
    s_waitcnt lgkmcnt(6)
    v_mfma_f32_16x16x32_bf16 v[40:43], v[96:99], v[72:75], v[40:43]
    ds_read_b128 v[72:75], v5 offset:17920
    v_mfma_f32_16x16x32_bf16 v[44:47], v[96:99], v[76:79], v[44:47]
    ds_read_b128 v[76:79], v5 offset:18176
    s_waitcnt lgkmcnt(6)
    v_mfma_f32_16x16x32_bf16 v[32:35], v[100:103], v[16:19], v[32:35]
    ds_read_b128 v[16:19], v5 offset:18432
    v_mfma_f32_16x16x32_bf16 v[36:39], v[100:103], v[20:23], v[36:39]
    ds_read_b128 v[20:23], v5 offset:18688
    s_waitcnt lgkmcnt(6)
    v_mfma_f32_16x16x32_bf16 v[40:43], v[100:103], v[24:27], v[40:43]
    ds_read_b128 v[24:27], v5 offset:18944
    v_mfma_f32_16x16x32_bf16 v[44:47], v[100:103], v[28:31], v[44:47]
    ds_read_b128 v[28:31], v5 offset:19200
    s_waitcnt lgkmcnt(6)
    v_mfma_f32_16x16x32_bf16 v[32:35], v[104:107], v[64:67], v[32:35]
    ds_read_b128 v[64:67], v5 offset:19456
    v_mfma_f32_16x16x32_bf16 v[36:39], v[104:107], v[68:71], v[36:39]
    ds_read_b128 v[68:71], v5 offset:19712
    s_waitcnt lgkmcnt(6)
    v_mfma_f32_16x16x32_bf16 v[40:43], v[104:107], v[72:75], v[40:43]
    ds_read_b128 v[72:75], v5 offset:19968
    v_mfma_f32_16x16x32_bf16 v[44:47], v[104:107], v[76:79], v[44:47]
    ds_read_b128 v[76:79], v5 offset:20224
    s_waitcnt lgkmcnt(6)
    v_mfma_f32_16x16x32_bf16 v[32:35], v[108:111], v[16:19], v[32:35]
    s_barrier
    ds_read_b128 v[16:19], v5 offset:32768
    v_mfma_f32_16x16x32_bf16 v[36:39], v[108:111], v[20:23], v[36:39]
    ds_read_b128 v[20:23], v5 offset:33024
    s_waitcnt lgkmcnt(6)
    v_mfma_f32_16x16x32_bf16 v[40:43], v[108:111], v[24:27], v[40:43]
    ds_read_b128 v[24:27], v5 offset:33280
    v_mfma_f32_16x16x32_bf16 v[44:47], v[108:111], v[28:31], v[44:47]
    ds_read_b128 v[28:31], v5 offset:33536
    s_waitcnt lgkmcnt(6)
    v_mfma_f32_16x16x32_bf16 v[32:35], v[112:115], v[64:67], v[32:35]
    ds_read_b128 v[64:67], v5 offset:33792
    v_mfma_f32_16x16x32_bf16 v[36:39], v[112:115], v[68:71], v[36:39]
    ds_read_b128 v[68:71], v5 offset:34048
    s_waitcnt lgkmcnt(6)
    v_mfma_f32_16x16x32_bf16 v[40:43], v[112:115], v[72:75], v[40:43]
    ds_read_b128 v[72:75], v5 offset:34304
    v_mfma_f32_16x16x32_bf16 v[44:47], v[112:115], v[76:79], v[44:47]
    ds_read_b128 v[76:79], v5 offset:34560
    s_waitcnt lgkmcnt(6)
    v_mfma_f32_16x16x32_bf16 v[32:35], v[116:119], v[16:19], v[32:35]
    ds_read_b128 v[16:19], v5 offset:34816
    v_mfma_f32_16x16x32_bf16 v[36:39], v[116:119], v[20:23], v[36:39]
    ds_read_b128 v[20:23], v5 offset:35072
    s_waitcnt lgkmcnt(6)
    v_mfma_f32_16x16x32_bf16 v[40:43], v[116:119], v[24:27], v[40:43]
    ds_read_b128 v[24:27], v5 offset:35328
    v_mfma_f32_16x16x32_bf16 v[44:47], v[116:119], v[28:31], v[44:47]
    ds_read_b128 v[28:31], v5 offset:35584
    s_waitcnt lgkmcnt(6)
    v_mfma_f32_16x16x32_bf16 v[32:35], v[120:123], v[64:67], v[32:35]
    ds_read_b128 v[64:67], v5 offset:35840
    v_mfma_f32_16x16x32_bf16 v[36:39], v[120:123], v[68:71], v[36:39]
    ds_read_b128 v[68:71], v5 offset:36096
    s_waitcnt lgkmcnt(6)
    v_mfma_f32_16x16x32_bf16 v[40:43], v[120:123], v[72:75], v[40:43]
    ds_read_b128 v[72:75], v5 offset:36352
    v_mfma_f32_16x16x32_bf16 v[44:47], v[120:123], v[76:79], v[44:47]
    ds_read_b128 v[76:79], v5 offset:36608
    s_waitcnt lgkmcnt(6)
    v_mfma_f32_16x16x32_bf16 v[32:35], v[124:127], v[16:19], v[32:35]
    s_barrier
    ds_read_b128 v[16:19], v5 offset:49152
    v_mfma_f32_16x16x32_bf16 v[36:39], v[124:127], v[20:23], v[36:39]
    ds_read_b128 v[20:23], v5 offset:49408
    s_waitcnt lgkmcnt(6)
    v_mfma_f32_16x16x32_bf16 v[40:43], v[124:127], v[24:27], v[40:43]
    ds_read_b128 v[24:27], v5 offset:49664
    v_mfma_f32_16x16x32_bf16 v[44:47], v[124:127], v[28:31], v[44:47]
    ds_read_b128 v[28:31], v5 offset:49920
    s_waitcnt lgkmcnt(6)
    v_mfma_f32_16x16x32_bf16 v[32:35], v[128:131], v[64:67], v[32:35]
    ds_read_b128 v[64:67], v5 offset:50176
    v_mfma_f32_16x16x32_bf16 v[36:39], v[128:131], v[68:71], v[36:39]
    ds_read_b128 v[68:71], v5 offset:50432
    s_waitcnt lgkmcnt(6)
    v_mfma_f32_16x16x32_bf16 v[40:43], v[128:131], v[72:75], v[40:43]
    ds_read_b128 v[72:75], v5 offset:50688
    v_mfma_f32_16x16x32_bf16 v[44:47], v[128:131], v[76:79], v[44:47]
    ds_read_b128 v[76:79], v5 offset:50944
    s_waitcnt lgkmcnt(6)
    v_mfma_f32_16x16x32_bf16 v[32:35], v[132:135], v[16:19], v[32:35]
    ds_read_b128 v[16:19], v5 offset:51200
    v_mfma_f32_16x16x32_bf16 v[36:39], v[132:135], v[20:23], v[36:39]
    ds_read_b128 v[20:23], v5 offset:51456
    s_waitcnt lgkmcnt(6)
    v_mfma_f32_16x16x32_bf16 v[40:43], v[132:135], v[24:27], v[40:43]
    ds_read_b128 v[24:27], v5 offset:51712
    v_mfma_f32_16x16x32_bf16 v[44:47], v[132:135], v[28:31], v[44:47]
    ds_read_b128 v[28:31], v5 offset:51968
    s_waitcnt lgkmcnt(6)
    v_mfma_f32_16x16x32_bf16 v[32:35], v[136:139], v[64:67], v[32:35]
    ds_read_b128 v[64:67], v5 offset:52224
    v_mfma_f32_16x16x32_bf16 v[36:39], v[136:139], v[68:71], v[36:39]
    ds_read_b128 v[68:71], v5 offset:52480
    s_waitcnt lgkmcnt(6)
    v_mfma_f32_16x16x32_bf16 v[40:43], v[136:139], v[72:75], v[40:43]
    ds_read_b128 v[72:75], v5 offset:52736
    v_mfma_f32_16x16x32_bf16 v[44:47], v[136:139], v[76:79], v[44:47]
    ds_read_b128 v[76:79], v5 offset:52992
    s_waitcnt lgkmcnt(6)
    v_mfma_f32_16x16x32_bf16 v[32:35], v[140:143], v[16:19], v[32:35]
    s_barrier
    ds_read_b128 v[16:19], v6 offset:0
    v_mfma_f32_16x16x32_bf16 v[36:39], v[140:143], v[20:23], v[36:39]
    ds_read_b128 v[20:23], v6 offset:256
    s_waitcnt lgkmcnt(6)
    v_mfma_f32_16x16x32_bf16 v[40:43], v[140:143], v[24:27], v[40:43]
    ds_read_b128 v[24:27], v6 offset:512
    v_mfma_f32_16x16x32_bf16 v[44:47], v[140:143], v[28:31], v[44:47]
    ds_read_b128 v[28:31], v6 offset:768
    s_waitcnt lgkmcnt(6)
    v_mfma_f32_16x16x32_bf16 v[32:35], v[144:147], v[64:67], v[32:35]
    ds_read_b128 v[64:67], v6 offset:1024
    v_mfma_f32_16x16x32_bf16 v[36:39], v[144:147], v[68:71], v[36:39]
    ds_read_b128 v[68:71], v6 offset:1280
    s_waitcnt lgkmcnt(6)
    v_mfma_f32_16x16x32_bf16 v[40:43], v[144:147], v[72:75], v[40:43]
    ds_read_b128 v[72:75], v6 offset:1536
    v_mfma_f32_16x16x32_bf16 v[44:47], v[144:147], v[76:79], v[44:47]
    ds_read_b128 v[76:79], v6 offset:1792
    s_waitcnt lgkmcnt(6)
    v_mfma_f32_16x16x32_bf16 v[32:35], v[148:151], v[16:19], v[32:35]
    ds_read_b128 v[16:19], v6 offset:2048
    v_mfma_f32_16x16x32_bf16 v[36:39], v[148:151], v[20:23], v[36:39]
    ds_read_b128 v[20:23], v6 offset:2304
    s_waitcnt lgkmcnt(6)
    v_mfma_f32_16x16x32_bf16 v[40:43], v[148:151], v[24:27], v[40:43]
    ds_read_b128 v[24:27], v6 offset:2560
    v_mfma_f32_16x16x32_bf16 v[44:47], v[148:151], v[28:31], v[44:47]
    ds_read_b128 v[28:31], v6 offset:2816
    s_waitcnt lgkmcnt(6)
    v_mfma_f32_16x16x32_bf16 v[32:35], v[152:155], v[64:67], v[32:35]
    ds_read_b128 v[64:67], v6 offset:3072
    v_mfma_f32_16x16x32_bf16 v[36:39], v[152:155], v[68:71], v[36:39]
    ds_read_b128 v[68:71], v6 offset:3328
    s_waitcnt lgkmcnt(6)
    v_mfma_f32_16x16x32_bf16 v[40:43], v[152:155], v[72:75], v[40:43]
    ds_read_b128 v[72:75], v6 offset:3584
    v_mfma_f32_16x16x32_bf16 v[44:47], v[152:155], v[76:79], v[44:47]
    ds_read_b128 v[76:79], v6 offset:3840
    s_waitcnt lgkmcnt(6)
    v_mfma_f32_16x16x32_bf16 v[32:35], v[156:159], v[16:19], v[32:35]
    s_barrier
    ds_read_b128 v[16:19], v6 offset:16384
    v_mfma_f32_16x16x32_bf16 v[36:39], v[156:159], v[20:23], v[36:39]
    ds_read_b128 v[20:23], v6 offset:16640
    s_waitcnt lgkmcnt(6)
    v_mfma_f32_16x16x32_bf16 v[40:43], v[156:159], v[24:27], v[40:43]
    ds_read_b128 v[24:27], v6 offset:16896
    v_mfma_f32_16x16x32_bf16 v[44:47], v[156:159], v[28:31], v[44:47]
    ds_read_b128 v[28:31], v6 offset:17152
    s_waitcnt lgkmcnt(6)
    v_mfma_f32_16x16x32_bf16 v[32:35], v[160:163], v[64:67], v[32:35]
    ds_read_b128 v[64:67], v6 offset:17408
    v_mfma_f32_16x16x32_bf16 v[36:39], v[160:163], v[68:71], v[36:39]
    ds_read_b128 v[68:71], v6 offset:17664
    s_waitcnt lgkmcnt(6)
    v_mfma_f32_16x16x32_bf16 v[40:43], v[160:163], v[72:75], v[40:43]
    ds_read_b128 v[72:75], v6 offset:17920
    v_mfma_f32_16x16x32_bf16 v[44:47], v[160:163], v[76:79], v[44:47]
    ds_read_b128 v[76:79], v6 offset:18176
    s_waitcnt lgkmcnt(6)
    v_mfma_f32_16x16x32_bf16 v[32:35], v[164:167], v[16:19], v[32:35]
    ds_read_b128 v[16:19], v6 offset:18432
    v_mfma_f32_16x16x32_bf16 v[36:39], v[164:167], v[20:23], v[36:39]
    ds_read_b128 v[20:23], v6 offset:18688
    s_waitcnt lgkmcnt(6)
    v_mfma_f32_16x16x32_bf16 v[40:43], v[164:167], v[24:27], v[40:43]
    ds_read_b128 v[24:27], v6 offset:18944
    v_mfma_f32_16x16x32_bf16 v[44:47], v[164:167], v[28:31], v[44:47]
    ds_read_b128 v[28:31], v6 offset:19200
    s_waitcnt lgkmcnt(6)
    v_mfma_f32_16x16x32_bf16 v[32:35], v[168:171], v[64:67], v[32:35]
    ds_read_b128 v[64:67], v6 offset:19456
    v_mfma_f32_16x16x32_bf16 v[36:39], v[168:171], v[68:71], v[36:39]
    ds_read_b128 v[68:71], v6 offset:19712
    s_waitcnt lgkmcnt(6)
    v_mfma_f32_16x16x32_bf16 v[40:43], v[168:171], v[72:75], v[40:43]
    ds_read_b128 v[72:75], v6 offset:19968
    v_mfma_f32_16x16x32_bf16 v[44:47], v[168:171], v[76:79], v[44:47]
    ds_read_b128 v[76:79], v6 offset:20224
    s_waitcnt lgkmcnt(6)
    v_mfma_f32_16x16x32_bf16 v[32:35], v[172:175], v[16:19], v[32:35]
    s_barrier
    ds_read_b128 v[16:19], v6 offset:32768
    v_mfma_f32_16x16x32_bf16 v[36:39], v[172:175], v[20:23], v[36:39]
    ds_read_b128 v[20:23], v6 offset:33024
    s_waitcnt lgkmcnt(6)
    v_mfma_f32_16x16x32_bf16 v[40:43], v[172:175], v[24:27], v[40:43]
    ds_read_b128 v[24:27], v6 offset:33280
    v_mfma_f32_16x16x32_bf16 v[44:47], v[172:175], v[28:31], v[44:47]
    ds_read_b128 v[28:31], v6 offset:33536
    s_waitcnt lgkmcnt(6)
    v_mfma_f32_16x16x32_bf16 v[32:35], v[176:179], v[64:67], v[32:35]
    ds_read_b128 v[64:67], v6 offset:33792
    v_mfma_f32_16x16x32_bf16 v[36:39], v[176:179], v[68:71], v[36:39]
    ds_read_b128 v[68:71], v6 offset:34048
    s_waitcnt lgkmcnt(6)
    v_mfma_f32_16x16x32_bf16 v[40:43], v[176:179], v[72:75], v[40:43]
    ds_read_b128 v[72:75], v6 offset:34304
    v_mfma_f32_16x16x32_bf16 v[44:47], v[176:179], v[76:79], v[44:47]
    ds_read_b128 v[76:79], v6 offset:34560
    s_waitcnt lgkmcnt(6)
    v_mfma_f32_16x16x32_bf16 v[32:35], v[180:183], v[16:19], v[32:35]
    ds_read_b128 v[16:19], v6 offset:34816
    v_mfma_f32_16x16x32_bf16 v[36:39], v[180:183], v[20:23], v[36:39]
    ds_read_b128 v[20:23], v6 offset:35072
    s_waitcnt lgkmcnt(6)
    v_mfma_f32_16x16x32_bf16 v[40:43], v[180:183], v[24:27], v[40:43]
    ds_read_b128 v[24:27], v6 offset:35328
    v_mfma_f32_16x16x32_bf16 v[44:47], v[180:183], v[28:31], v[44:47]
    ds_read_b128 v[28:31], v6 offset:35584
    s_waitcnt lgkmcnt(6)
    v_mfma_f32_16x16x32_bf16 v[32:35], v[184:187], v[64:67], v[32:35]
    ds_read_b128 v[64:67], v6 offset:35840
    v_mfma_f32_16x16x32_bf16 v[36:39], v[184:187], v[68:71], v[36:39]
    ds_read_b128 v[68:71], v6 offset:36096
    s_waitcnt lgkmcnt(6)
    v_mfma_f32_16x16x32_bf16 v[40:43], v[184:187], v[72:75], v[40:43]
    ds_read_b128 v[72:75], v6 offset:36352
    v_mfma_f32_16x16x32_bf16 v[44:47], v[184:187], v[76:79], v[44:47]
    ds_read_b128 v[76:79], v6 offset:36608
    s_waitcnt lgkmcnt(6)
    v_mfma_f32_16x16x32_bf16 v[32:35], v[188:191], v[16:19], v[32:35]
    s_barrier
    ds_read_b128 v[16:19], v6 offset:49152
    v_mfma_f32_16x16x32_bf16 v[36:39], v[188:191], v[20:23], v[36:39]
    ds_read_b128 v[20:23], v6 offset:49408
    s_waitcnt lgkmcnt(6)
    v_mfma_f32_16x16x32_bf16 v[40:43], v[188:191], v[24:27], v[40:43]
    ds_read_b128 v[24:27], v6 offset:49664
    v_mfma_f32_16x16x32_bf16 v[44:47], v[188:191], v[28:31], v[44:47]
    ds_read_b128 v[28:31], v6 offset:49920
    s_waitcnt lgkmcnt(6)
    v_mfma_f32_16x16x32_bf16 v[32:35], v[192:195], v[64:67], v[32:35]
    ds_read_b128 v[64:67], v6 offset:50176
    v_mfma_f32_16x16x32_bf16 v[36:39], v[192:195], v[68:71], v[36:39]
    ds_read_b128 v[68:71], v6 offset:50432
    s_waitcnt lgkmcnt(6)
    v_mfma_f32_16x16x32_bf16 v[40:43], v[192:195], v[72:75], v[40:43]
    ds_read_b128 v[72:75], v6 offset:50688
    v_mfma_f32_16x16x32_bf16 v[44:47], v[192:195], v[76:79], v[44:47]
    ds_read_b128 v[76:79], v6 offset:50944
    s_waitcnt lgkmcnt(6)
    v_mfma_f32_16x16x32_bf16 v[32:35], v[196:199], v[16:19], v[32:35]
    ds_read_b128 v[16:19], v6 offset:51200
    v_mfma_f32_16x16x32_bf16 v[36:39], v[196:199], v[20:23], v[36:39]
    ds_read_b128 v[20:23], v6 offset:51456
    s_waitcnt lgkmcnt(6)
    v_mfma_f32_16x16x32_bf16 v[40:43], v[196:199], v[24:27], v[40:43]
    ds_read_b128 v[24:27], v6 offset:51712
    v_mfma_f32_16x16x32_bf16 v[44:47], v[196:199], v[28:31], v[44:47]
    ds_read_b128 v[28:31], v6 offset:51968
    s_waitcnt lgkmcnt(6)
    v_mfma_f32_16x16x32_bf16 v[32:35], v[200:203], v[64:67], v[32:35]
    ds_read_b128 v[64:67], v6 offset:52224
    v_mfma_f32_16x16x32_bf16 v[36:39], v[200:203], v[68:71], v[36:39]
    ds_read_b128 v[68:71], v6 offset:52480
    s_waitcnt lgkmcnt(6)
    v_mfma_f32_16x16x32_bf16 v[40:43], v[200:203], v[72:75], v[40:43]
    ds_read_b128 v[72:75], v6 offset:52736
    v_mfma_f32_16x16x32_bf16 v[44:47], v[200:203], v[76:79], v[44:47]
    ds_read_b128 v[76:79], v6 offset:52992
    s_waitcnt lgkmcnt(6)
    v_mfma_f32_16x16x32_bf16 v[32:35], v[204:207], v[16:19], v[32:35]
    s_barrier
    ds_read_b128 v[16:19], v7 offset:0
    v_mfma_f32_16x16x32_bf16 v[36:39], v[204:207], v[20:23], v[36:39]
    ds_read_b128 v[20:23], v7 offset:256
    s_waitcnt lgkmcnt(6)
    v_mfma_f32_16x16x32_bf16 v[40:43], v[204:207], v[24:27], v[40:43]
    ds_read_b128 v[24:27], v7 offset:512
    v_mfma_f32_16x16x32_bf16 v[44:47], v[204:207], v[28:31], v[44:47]
    ds_read_b128 v[28:31], v7 offset:768
    s_waitcnt lgkmcnt(6)
    v_mfma_f32_16x16x32_bf16 v[32:35], v[208:211], v[64:67], v[32:35]
    ds_read_b128 v[64:67], v7 offset:1024
    v_mfma_f32_16x16x32_bf16 v[36:39], v[208:211], v[68:71], v[36:39]
    ds_read_b128 v[68:71], v7 offset:1280
    s_waitcnt lgkmcnt(6)
    v_mfma_f32_16x16x32_bf16 v[40:43], v[208:211], v[72:75], v[40:43]
    ds_read_b128 v[72:75], v7 offset:1536
    v_mfma_f32_16x16x32_bf16 v[44:47], v[208:211], v[76:79], v[44:47]
    ds_read_b128 v[76:79], v7 offset:1792
    s_waitcnt lgkmcnt(6)
    v_mfma_f32_16x16x32_bf16 v[32:35], v[212:215], v[16:19], v[32:35]
    ds_read_b128 v[16:19], v7 offset:2048
    v_mfma_f32_16x16x32_bf16 v[36:39], v[212:215], v[20:23], v[36:39]
    ds_read_b128 v[20:23], v7 offset:2304
    s_waitcnt lgkmcnt(6)
    v_mfma_f32_16x16x32_bf16 v[40:43], v[212:215], v[24:27], v[40:43]
    ds_read_b128 v[24:27], v7 offset:2560
    v_mfma_f32_16x16x32_bf16 v[44:47], v[212:215], v[28:31], v[44:47]
    ds_read_b128 v[28:31], v7 offset:2816
    s_waitcnt lgkmcnt(6)
    v_mfma_f32_16x16x32_bf16 v[32:35], v[216:219], v[64:67], v[32:35]
    ds_read_b128 v[64:67], v7 offset:3072
    v_mfma_f32_16x16x32_bf16 v[36:39], v[216:219], v[68:71], v[36:39]
    ds_read_b128 v[68:71], v7 offset:3328
    s_waitcnt lgkmcnt(6)
    v_mfma_f32_16x16x32_bf16 v[40:43], v[216:219], v[72:75], v[40:43]
    ds_read_b128 v[72:75], v7 offset:3584
    v_mfma_f32_16x16x32_bf16 v[44:47], v[216:219], v[76:79], v[44:47]
    ds_read_b128 v[76:79], v7 offset:3840
    s_waitcnt lgkmcnt(6)
    v_mfma_f32_16x16x32_bf16 v[32:35], v[220:223], v[16:19], v[32:35]
    s_barrier
    ds_read_b128 v[16:19], v5 offset:0
    v_mfma_f32_16x16x32_bf16 v[36:39], v[220:223], v[20:23], v[36:39]
    ds_read_b128 v[20:23], v5 offset:256
    s_waitcnt lgkmcnt(6)
    v_mfma_f32_16x16x32_bf16 v[40:43], v[220:223], v[24:27], v[40:43]
    ds_read_b128 v[24:27], v5 offset:512
    v_mfma_f32_16x16x32_bf16 v[44:47], v[220:223], v[28:31], v[44:47]
    ds_read_b128 v[28:31], v5 offset:768
    s_waitcnt lgkmcnt(6)
    v_mfma_f32_16x16x32_bf16 v[32:35], v[224:227], v[64:67], v[32:35]
    ds_read_b128 v[64:67], v5 offset:1024
    v_mfma_f32_16x16x32_bf16 v[36:39], v[224:227], v[68:71], v[36:39]
    ds_read_b128 v[68:71], v5 offset:1280
    s_waitcnt lgkmcnt(6)
    v_mfma_f32_16x16x32_bf16 v[40:43], v[224:227], v[72:75], v[40:43]
    ds_read_b128 v[72:75], v5 offset:1536
    v_mfma_f32_16x16x32_bf16 v[44:47], v[224:227], v[76:79], v[44:47]
    ds_read_b128 v[76:79], v5 offset:1792
    s_waitcnt lgkmcnt(6)
    v_mfma_f32_16x16x32_bf16 v[32:35], v[228:231], v[16:19], v[32:35]
    ds_read_b128 v[16:19], v5 offset:2048
    v_mfma_f32_16x16x32_bf16 v[36:39], v[228:231], v[20:23], v[36:39]
    ds_read_b128 v[20:23], v5 offset:2304
    s_waitcnt lgkmcnt(6)
    v_mfma_f32_16x16x32_bf16 v[40:43], v[228:231], v[24:27], v[40:43]
    ds_read_b128 v[24:27], v5 offset:2560
    v_mfma_f32_16x16x32_bf16 v[44:47], v[228:231], v[28:31], v[44:47]
    ds_read_b128 v[28:31], v5 offset:2816
    s_waitcnt lgkmcnt(6)
    v_mfma_f32_16x16x32_bf16 v[32:35], v[232:235], v[64:67], v[32:35]
    ds_read_b128 v[64:67], v5 offset:3072
    v_mfma_f32_16x16x32_bf16 v[36:39], v[232:235], v[68:71], v[36:39]
    ds_read_b128 v[68:71], v5 offset:3328
    s_waitcnt lgkmcnt(6)
    v_mfma_f32_16x16x32_bf16 v[40:43], v[232:235], v[72:75], v[40:43]
    ds_read_b128 v[72:75], v5 offset:3584
    v_mfma_f32_16x16x32_bf16 v[44:47], v[232:235], v[76:79], v[44:47]
    ds_read_b128 v[76:79], v5 offset:3840
    s_waitcnt lgkmcnt(6)
    v_mfma_f32_16x16x32_bf16 v[32:35], v[236:239], v[16:19], v[32:35]
    s_barrier
    ds_read_b128 v[16:19], v5 offset:16384
    v_mfma_f32_16x16x32_bf16 v[36:39], v[236:239], v[20:23], v[36:39]
    ds_read_b128 v[20:23], v5 offset:16640
    s_waitcnt lgkmcnt(6)
    v_mfma_f32_16x16x32_bf16 v[40:43], v[236:239], v[24:27], v[40:43]
    ds_read_b128 v[24:27], v5 offset:16896
    v_mfma_f32_16x16x32_bf16 v[44:47], v[236:239], v[28:31], v[44:47]
    ds_read_b128 v[28:31], v5 offset:17152
    s_waitcnt lgkmcnt(6)
    v_mfma_f32_16x16x32_bf16 v[32:35], v[240:243], v[64:67], v[32:35]
    ds_read_b128 v[64:67], v5 offset:17408
    v_mfma_f32_16x16x32_bf16 v[36:39], v[240:243], v[68:71], v[36:39]
    ds_read_b128 v[68:71], v5 offset:17664
    s_waitcnt lgkmcnt(6)
    v_mfma_f32_16x16x32_bf16 v[40:43], v[240:243], v[72:75], v[40:43]
    ds_read_b128 v[72:75], v5 offset:17920
    v_mfma_f32_16x16x32_bf16 v[44:47], v[240:243], v[76:79], v[44:47]
    ds_read_b128 v[76:79], v5 offset:18176
    s_waitcnt lgkmcnt(6)
    v_mfma_f32_16x16x32_bf16 v[32:35], v[244:247], v[16:19], v[32:35]
    ds_read_b128 v[16:19], v5 offset:18432
    v_mfma_f32_16x16x32_bf16 v[36:39], v[244:247], v[20:23], v[36:39]
    ds_read_b128 v[20:23], v5 offset:18688
    s_waitcnt lgkmcnt(6)
    v_mfma_f32_16x16x32_bf16 v[40:43], v[244:247], v[24:27], v[40:43]
    ds_read_b128 v[24:27], v5 offset:18944
    v_mfma_f32_16x16x32_bf16 v[44:47], v[244:247], v[28:31], v[44:47]
    ds_read_b128 v[28:31], v5 offset:19200
    s_waitcnt lgkmcnt(6)
    v_mfma_f32_16x16x32_bf16 v[32:35], v[248:251], v[64:67], v[32:35]
    v_mfma_f32_16x16x32_bf16 v[36:39], v[248:251], v[68:71], v[36:39]
    s_waitcnt lgkmcnt(4)
    v_mfma_f32_16x16x32_bf16 v[40:43], v[248:251], v[72:75], v[40:43]
    v_mfma_f32_16x16x32_bf16 v[44:47], v[248:251], v[76:79], v[44:47]
    s_waitcnt lgkmcnt(2)
    v_mfma_f32_16x16x32_bf16 v[32:35], v[252:255], v[16:19], v[32:35]
    v_mfma_f32_16x16x32_bf16 v[36:39], v[252:255], v[20:23], v[36:39]
    s_waitcnt lgkmcnt(0)
    v_mfma_f32_16x16x32_bf16 v[40:43], v[252:255], v[24:27], v[40:43]
    v_mfma_f32_16x16x32_bf16 v[44:47], v[252:255], v[28:31], v[44:47]
    s_nop 3
    v_pk_fma_f32 v[48:49], v[32:33], v[80:81], v[48:49]
    v_pk_fma_f32 v[50:51], v[34:35], v[82:83], v[50:51]
    v_pk_fma_f32 v[52:53], v[36:37], v[80:81], v[52:53]
    v_pk_fma_f32 v[54:55], v[38:39], v[82:83], v[54:55]
    v_pk_fma_f32 v[56:57], v[40:41], v[80:81], v[56:57]
    v_pk_fma_f32 v[58:59], v[42:43], v[82:83], v[58:59]
    v_pk_fma_f32 v[60:61], v[44:45], v[80:81], v[60:61]
    v_pk_fma_f32 v[62:63], v[46:47], v[82:83], v[62:63]
    v_cvt_pk_bf16_f32 v16, v48, v49
    v_cvt_pk_bf16_f32 v17, v50, v51
    v_cvt_pk_bf16_f32 v18, v52, v53
    v_cvt_pk_bf16_f32 v19, v54, v55
    v_cvt_pk_bf16_f32 v20, v56, v57
    v_cvt_pk_bf16_f32 v21, v58, v59
    v_cvt_pk_bf16_f32 v22, v60, v61
    v_cvt_pk_bf16_f32 v23, v62, v63
    v_permlane16_swap_b32 v16, v18
    v_permlane16_swap_b32 v17, v19
    v_permlane16_swap_b32 v20, v22
    v_permlane16_swap_b32 v21, v23
    buffer_store_dwordx4 v[16:19], v2, s[44:47], 0 offen
    buffer_store_dwordx4 v[20:23], v2, s[44:47], s71 offen
    s_endpgm
L_exit:
    s_endpgm
L_codeend:
.section .rodata,"a"
.p2align 6
.amdhsa_kernel adaLN_cond__sliding_local_dilated__mixer_s_mlp__prompt_kernel
  .amdhsa_next_free_vgpr 256
  .amdhsa_next_free_sgpr 102
  .amdhsa_accum_offset 256
  .amdhsa_group_segment_fixed_size 0
  .amdhsa_kernarg_size 104
  .amdhsa_user_sgpr_count 2
  .amdhsa_user_sgpr_kernarg_segment_ptr 1
  .amdhsa_system_sgpr_workgroup_id_x 1
.end_amdhsa_kernel
```
